```python
import torch

def _softmax(x, axis=-1):
    return torch.softmax(x, dim=axis)

def _gelu(x):
    return torch.nn.functional.gelu(x, approximate='tanh')

def _silu(x):
    return torch.nn.functional.silu(x)

def _sigmoid(x):
    return torch.sigmoid(x)

def _layernorm(x, axis=-1, eps=1e-05):
    m = x.mean(dim=axis, keepdim=True)
    v = x.var(dim=axis, keepdim=True, unbiased=False)
    return (x - m) / torch.sqrt(v + eps)

def _scatter_add(tgt, idx, src, axis=0):
    return tgt.clone().index_add_(axis, idx, src)

def _segment_sum(src, seg, n):
    out = torch.zeros((n,) + src.shape[1:], dtype=src.dtype)
    return out.index_add_(0, seg, src)

def _pad(x, pw):
    flat = tuple((v for pair in reversed(pw) for v in pair))
    return torch.nn.functional.pad(x, flat)
kernel_name = 'standalone__swin_window_attn__vision'

def setup_inputs():

    _w = lambda a: (lambda t: t.to(torch.bfloat16) if t.is_floating_point() else t)(torch.as_tensor(a))
    H = W = 224 // 8 * 8
    C, win = (192, 8)
    return {'x': _w((lambda *s: torch.randn(*s, dtype=torch.bfloat16) * 0.2)(1, H, W, C)), 'wqkv': _w((lambda *s: torch.randn(*s, dtype=torch.bfloat16) * 0.2)(C, 3 * C)), 'wo': _w((lambda *s: torch.randn(*s, dtype=torch.bfloat16) * 0.05)(C, C))}

def reference(x, wqkv, wo):
    B, H, W, C = x.shape
    win = 8
    nh, nw = (H // win, W // win)
    xw = (lambda x, *d: x.permute(*d))(x.reshape(B, nh, win, nw, win, C), 0, 1, 3, 2, 4, 5)
    xw = xw.reshape(B * nh * nw, win * win, C)
    qkv = xw @ wqkv
    q, k, v = (qkv[..., :C].clone(), qkv[..., C:2 * C].clone(), qkv[..., 2 * C:].clone())
    scale = C ** (-0.5)
    p = _softmax(torch.einsum('bqc,bkc->bqk', q, k) * scale, axis=-1)
    o = torch.einsum('bqk,bkc->bqc', p, v) @ wo
    o = (lambda x, *d: x.permute(*d))(o.reshape(B, nh, nw, win, win, C), 0, 1, 3, 2, 4, 5)
    return o.reshape(B, H, W, C)
```

```asm
; @launch grid=(244,1,1) block=(256,1,1) lds=163840
.amdgcn_target "amdgcn-amd-amdhsa--gfx950"
.text
.globl standalone__swin_window_attn__vision_kernel
.type standalone__swin_window_attn__vision_kernel,@function
.p2align 12
.p2align 8
standalone__swin_window_attn__vision_kernel:
    s_load_dwordx8 s[4:11], s[0:1], 0
    s_load_dwordx4 s[12:15], s[0:1], 32
    s_getpc_b64 s[50:51]
pcref:
    s_sub_u32 s50, s50, pcref-standalone__swin_window_attn__vision_kernel
    s_subb_u32 s51, s51, 0
    v_lshlrev_b32 v15, 7, v0
    v_min_u32 v15, code_end-standalone__swin_window_attn__vision_kernel-4, v15
    global_load_dword v15, v15, s[50:51]
    v_lshrrev_b32 v1, 6, v0
    v_and_b32 v0, 63, v0
    v_readfirstlane_b32 s3, v1
    s_and_b32 s53, s2, 7
    s_cmp_ge_u32 s2, 48
    s_cbranch_scc0 prod
cons:
    s_cmp_ge_u32 s2, 244
    s_cbranch_scc1 done
    s_sub_u32 s48, s2, 48
    s_lshr_b32 s58, s48, 3
    s_min_u32 s58, s58, 23
    v_mov_b32 v26, 384
    s_lshl_b32 s59, s58, 2
    s_add_u32 s59, s59, s3
    s_mul_i32 s40, s59, 2304
    v_min_u32 v25, 11, v0
    v_cmp_lt_u32 vcc, 5, v25
    v_lshlrev_b32 v25, 7, v25
    v_add_u32 v25, s40, v25
    v_cndmask_b32 v24, 0, v26, vcc
    v_add_u32 v25, v25, v24
    s_mul_i32 s32, s48, 4682
    s_lshr_b32 s32, s32, 16
    s_mul_i32 s33, s32, 14
    s_sub_u32 s33, s48, s33
    s_mul_i32 s32, s32, 1376256
    s_mul_i32 s33, s33, 6144
    s_add_u32 s32, s32, s33
    s_lshr_b32 s34, s3, 1
    s_mul_i32 s34, s34, 3072
    s_add_u32 s32, s32, s34
    s_and_b32 s52, s3, 1
    s_mul_i32 s33, s52, 344064
    s_add_u32 s32, s32, s33
    s_add_u32 s33, s32, 86016
    s_add_u32 s34, s33, 86016
    s_add_u32 s35, s34, 86016
    s_mul_i32 s49, s3, 22528
    s_add_u32 s49, s49, 73728
    v_add_u32 v1, 0, v0
    v_mul_u32_u24 v2, 2731, v1
    v_lshrrev_b32 v2, 16, v2
    v_and_b32 v2, 2, v2
    v_xor_b32 v1, v0, v2
    v_lshlrev_b32 v252, 4, v1
    v_add_u32 v1, 64, v0
    v_mul_u32_u24 v2, 2731, v1
    v_lshrrev_b32 v2, 16, v2
    v_and_b32 v2, 2, v2
    v_xor_b32 v1, v0, v2
    v_lshlrev_b32 v253, 4, v1
    v_add_u32 v1, 128, v0
    v_mul_u32_u24 v2, 2731, v1
    v_lshrrev_b32 v2, 16, v2
    v_and_b32 v2, 2, v2
    v_xor_b32 v1, v0, v2
    v_lshlrev_b32 v254, 4, v1
    s_waitcnt lgkmcnt(0)
    global_load_dword v25, v25, s[6:7]
    s_mov_b32 s16, s4
    s_and_b32 s17, s5, 0xffff
    s_mov_b32 s18, 19267584
    s_mov_b32 s19, 0x20000
    s_add_u32 m0, s49, 0
    s_nop 0
    buffer_load_dwordx4 v252, s[16:19], s32 offen offset:0 nt lds
    buffer_load_dwordx4 v253, s[16:19], s32 offen offset:1024 nt lds
    buffer_load_dwordx4 v254, s[16:19], s32 offen offset:2048 nt lds
    s_add_u32 m0, s49, 3136
    s_nop 0
    buffer_load_dwordx4 v252, s[16:19], s33 offen offset:0 nt lds
    buffer_load_dwordx4 v253, s[16:19], s33 offen offset:1024 nt lds
    buffer_load_dwordx4 v254, s[16:19], s33 offen offset:2048 nt lds
    s_mul_i32 s54, s53, 151552
    s_add_u32 s54, s54, 524288
    s_mul_i32 s41, s59, 768
    s_add_u32 s41, s41, s54
    s_lshl_b32 s40, s58, 7
    s_add_u32 s40, s40, s54
    s_add_u32 s40, s40, 147456
    v_lshlrev_b32 v22, 7, v0
    v_add_u32 v22, s41, v22
    v_mov_b32 v23, s40
    v_cmp_lt_u32 vcc, 5, v0
    s_nop 1
    v_cndmask_b32 v22, v22, v23, vcc
    global_load_dword v22, v22, s[14:15]
    s_add_u32 m0, s49, 6272
    s_nop 0
    buffer_load_dwordx4 v252, s[16:19], s34 offen offset:0 nt lds
    buffer_load_dwordx4 v253, s[16:19], s34 offen offset:1024 nt lds
    buffer_load_dwordx4 v254, s[16:19], s34 offen offset:2048 nt lds
    s_add_u32 m0, s49, 9408
    s_nop 0
    buffer_load_dwordx4 v252, s[16:19], s35 offen offset:0 nt lds
    buffer_load_dwordx4 v253, s[16:19], s35 offen offset:1024 nt lds
    buffer_load_dwordx4 v254, s[16:19], s35 offen offset:2048 nt lds
    s_branch cons2
prod:
    s_memrealtime s[56:57]
    s_lshr_b32 s52, s2, 3
    s_and_b32 s32, s52, 1
    s_lshr_b32 s33, s52, 1
    v_lshrrev_b32 v1, 3, v0
    v_and_b32 v2, 2, v1
    v_and_b32 v3, 7, v0
    v_xor_b32 v2, v2, v3
    v_mul_u32_u24 v1, 1152, v1
    v_lshl_add_u32 v8, v2, 4, v1
    s_mul_i32 s34, s33, 73728
    s_mul_i32 s36, s3, 9216
    s_add_u32 s34, s34, s36
    s_mul_i32 s35, s32, 110592
    s_add_u32 s35, s35, s36
    s_add_u32 s35, s35, 384
    s_mul_i32 s37, s3, 3072
    s_lshr_b32 s36, s3, 1
    s_lshl_b32 s36, s36, 6
    s_add_u32 s37, s37, s36
    s_add_u32 s99, s34, 36864
    s_add_u32 s100, s35, 36864
    s_add_u32 s101, s100, 36864
    s_waitcnt lgkmcnt(0)
    s_mov_b32 s16, s6
    s_and_b32 s17, s7, 0xffff
    s_mov_b32 s18, 221184
    s_mov_b32 s19, 0x20000
    s_add_u32 m0, s37, 0
    s_nop 0
    buffer_load_dwordx4 v8, s[16:19], s34 offen offset:0 lds
    s_add_u32 m0, s37, 12416
    s_nop 0
    buffer_load_dwordx4 v8, s[16:19], s99 offen offset:0 lds
    s_add_u32 m0, s37, 24832
    s_nop 0
    buffer_load_dwordx4 v8, s[16:19], s35 offen offset:0 lds
    s_add_u32 m0, s37, 37248
    s_nop 0
    buffer_load_dwordx4 v8, s[16:19], s100 offen offset:0 lds
    s_add_u32 m0, s37, 49664
    s_nop 0
    buffer_load_dwordx4 v8, s[16:19], s101 offen offset:0 lds
    s_mov_b32 s28, s12
    s_and_b32 s29, s13, 0xffff
    s_mov_b32 s30, 256
    s_mov_b32 s31, 0x20000
    s_or_b32 s44, s2, s3
    s_cbranch_scc1 nononce
    v_mov_b32 v6, s56
    v_mov_b32 v7, s57
    v_lshlrev_b32 v5, 6, v0
    buffer_store_dwordx2 v[6:7], v5, s[28:31], 0 offen sc0 sc1
nononce:
    s_add_u32 m0, s37, 896
    s_nop 0
    buffer_load_dwordx4 v8, s[16:19], s34 offen offset:128 lds
    s_add_u32 m0, s37, 13312
    s_nop 0
    buffer_load_dwordx4 v8, s[16:19], s99 offen offset:128 lds
    s_add_u32 m0, s37, 25728
    s_nop 0
    buffer_load_dwordx4 v8, s[16:19], s35 offen offset:128 lds
    s_add_u32 m0, s37, 38144
    s_nop 0
    buffer_load_dwordx4 v8, s[16:19], s100 offen offset:128 lds
    s_add_u32 m0, s37, 50560
    s_nop 0
    buffer_load_dwordx4 v8, s[16:19], s101 offen offset:128 lds
    s_mov_b32 s24, s14
    s_and_b32 s25, s15, 0xffff
    s_mov_b32 s26, 1736704
    s_mov_b32 s27, 0x20000
    s_mov_b32 s20, s8
    s_and_b32 s21, s9, 0xffff
    s_mov_b32 s22, 73728
    s_mov_b32 s23, 0x20000
    v_and_b32 v1, 15, v0
    v_lshrrev_b32 v2, 4, v0
    v_lshrrev_b32 v3, 2, v1
    v_mul_u32_u24 v3, 3072, v3
    v_and_b32 v4, 3, v1
    v_lshl_add_u32 v3, v4, 7, v3
    v_and_b32 v4, 2, v1
    v_xor_b32 v4, v2, v4
    v_lshl_add_u32 v3, v4, 4, v3
    v_and_b32 v4, 8, v1
    v_lshl_add_u32 v3, v4, 3, v3
    s_lshr_b32 s36, s3, 1
    s_mul_i32 s36, s36, 12416
    v_add_u32 v4, s36, v3
    s_and_b32 s36, s3, 1
    s_mul_i32 s45, s36, 512
    s_add_u32 s45, s45, 24832
    v_add_u32 v3, s45, v3
    v_lshlrev_b32 v5, 4, v0
    s_mul_i32 s39, s53, 151552
    s_add_u32 s39, s39, 524288
    s_mul_i32 s40, s32, 36
    s_lshl_b32 s41, s33, 2
    s_add_u32 s40, s40, s41
    s_add_u32 s40, s40, s3
    s_lshl_b32 s40, s40, 10
    s_lshl_b32 s54, s52, 2
    s_add_u32 s54, s54, s3
    s_lshl_b32 s43, s54, 3
    s_add_u32 s43, s43, s39
    s_add_u32 s43, s43, 147456
    s_lshl_b32 s55, s52, 3
    s_add_u32 s55, s55, s39
    s_add_u32 s55, s55, 148480
    v_lshlrev_b32 v61, 6, v0
    s_getreg_b32 s41, hwreg(HW_REG_XCC_ID, 0, 4)
    s_add_u32 s42, s40, s39
    s_add_u32 m0, s37, 1792
    s_nop 0
    buffer_load_dwordx4 v8, s[16:19], s34 offen offset:256 lds
    s_add_u32 m0, s37, 14208
    s_nop 0
    buffer_load_dwordx4 v8, s[16:19], s99 offen offset:256 lds
    s_add_u32 m0, s37, 26624
    s_nop 0
    buffer_load_dwordx4 v8, s[16:19], s35 offen offset:256 lds
    s_add_u32 m0, s37, 39040
    s_nop 0
    buffer_load_dwordx4 v8, s[16:19], s100 offen offset:256 lds
    s_add_u32 m0, s37, 51456
    s_nop 0
    buffer_load_dwordx4 v8, s[16:19], s101 offen offset:256 lds
    s_add_u32 s34, s34, 768
    s_waitcnt vmcnt(10)
    s_barrier
    ds_read_b128 v[64:67], v4 offset:0
    ds_read_b128 v[68:71], v4 offset:512
    ds_read_b128 v[72:75], v3 offset:0
    ds_read_b128 v[76:79], v3 offset:12416
    ds_read_b128 v[80:83], v3 offset:24832
    ds_read_b128 v[84:87], v4 offset:64
    ds_read_b128 v[88:91], v4 offset:576
    ds_read_b128 v[92:95], v3 offset:64
    ds_read_b128 v[96:99], v3 offset:12480
    ds_read_b128 v[100:103], v3 offset:24896
    buffer_load_dwordx2 v[6:7], off, s[28:31], 0 offset:128 sc1
    s_waitcnt lgkmcnt(7)
    v_mfma_f32_16x16x32_bf16 v[16:19], v[64:67], v[72:75], 0
    v_mfma_f32_16x16x32_bf16 v[20:23], v[68:71], v[72:75], 0
    s_waitcnt lgkmcnt(6)
    v_mfma_f32_16x16x32_bf16 v[24:27], v[64:67], v[76:79], 0
    v_mfma_f32_16x16x32_bf16 v[28:31], v[68:71], v[76:79], 0
    s_waitcnt lgkmcnt(5)
    v_mfma_f32_16x16x32_bf16 v[32:35], v[64:67], v[80:83], 0
    v_mfma_f32_16x16x32_bf16 v[36:39], v[68:71], v[80:83], 0
    s_waitcnt vmcnt(6)
    s_barrier
    ds_read_b128 v[104:107], v4 offset:1024
    ds_read_b128 v[108:111], v4 offset:1536
    ds_read_b128 v[112:115], v3 offset:1024
    ds_read_b128 v[116:119], v3 offset:13440
    ds_read_b128 v[120:123], v3 offset:25856
    ds_read_b128 v[124:127], v4 offset:1088
    ds_read_b128 v[128:131], v4 offset:1600
    ds_read_b128 v[132:135], v3 offset:1088
    ds_read_b128 v[136:139], v3 offset:13504
    ds_read_b128 v[140:143], v3 offset:25920
    s_waitcnt lgkmcnt(12)
    v_mfma_f32_16x16x32_bf16 v[16:19], v[84:87], v[92:95], v[16:19]
    v_mfma_f32_16x16x32_bf16 v[20:23], v[88:91], v[92:95], v[20:23]
    s_waitcnt lgkmcnt(11)
    v_mfma_f32_16x16x32_bf16 v[24:27], v[84:87], v[96:99], v[24:27]
    v_mfma_f32_16x16x32_bf16 v[28:31], v[88:91], v[96:99], v[28:31]
    s_waitcnt lgkmcnt(10)
    v_mfma_f32_16x16x32_bf16 v[32:35], v[84:87], v[100:103], v[32:35]
    v_mfma_f32_16x16x32_bf16 v[36:39], v[88:91], v[100:103], v[36:39]
    s_waitcnt lgkmcnt(7)
    v_mfma_f32_16x16x32_bf16 v[16:19], v[104:107], v[112:115], v[16:19]
    v_mfma_f32_16x16x32_bf16 v[20:23], v[108:111], v[112:115], v[20:23]
    s_waitcnt lgkmcnt(6)
    v_mfma_f32_16x16x32_bf16 v[24:27], v[104:107], v[116:119], v[24:27]
    v_mfma_f32_16x16x32_bf16 v[28:31], v[108:111], v[116:119], v[28:31]
    s_waitcnt lgkmcnt(5)
    v_mfma_f32_16x16x32_bf16 v[32:35], v[104:107], v[120:123], v[32:35]
    v_mfma_f32_16x16x32_bf16 v[36:39], v[108:111], v[120:123], v[36:39]
    s_waitcnt vmcnt(1)
    s_barrier
    ds_read_b128 v[144:147], v4 offset:2048
    ds_read_b128 v[148:151], v4 offset:2560
    ds_read_b128 v[152:155], v3 offset:2048
    ds_read_b128 v[164:167], v4 offset:2112
    ds_read_b128 v[168:171], v4 offset:2624
    ds_read_b128 v[172:175], v3 offset:2112
    ds_read_b128 v[156:159], v3 offset:14464
    ds_read_b128 v[176:179], v3 offset:14528
    ds_read_b128 v[160:163], v3 offset:26880
    ds_read_b128 v[180:183], v3 offset:26944
    s_waitcnt lgkmcnt(12)
    v_mfma_f32_16x16x32_bf16 v[16:19], v[124:127], v[132:135], v[16:19]
    v_mfma_f32_16x16x32_bf16 v[20:23], v[128:131], v[132:135], v[20:23]
    s_waitcnt lgkmcnt(11)
    v_mfma_f32_16x16x32_bf16 v[24:27], v[124:127], v[136:139], v[24:27]
    v_mfma_f32_16x16x32_bf16 v[28:31], v[128:131], v[136:139], v[28:31]
    s_waitcnt lgkmcnt(10)
    v_mfma_f32_16x16x32_bf16 v[32:35], v[124:127], v[140:143], v[32:35]
    v_mfma_f32_16x16x32_bf16 v[36:39], v[128:131], v[140:143], v[36:39]
    s_waitcnt lgkmcnt(7)
    v_mfma_f32_16x16x32_bf16 v[16:19], v[144:147], v[152:155], v[16:19]
    v_mfma_f32_16x16x32_bf16 v[20:23], v[148:151], v[152:155], v[20:23]
    s_waitcnt lgkmcnt(4)
    v_mfma_f32_16x16x32_bf16 v[16:19], v[164:167], v[172:175], v[16:19]
    v_mfma_f32_16x16x32_bf16 v[20:23], v[168:171], v[172:175], v[20:23]
    s_waitcnt lgkmcnt(3)
    v_mfma_f32_16x16x32_bf16 v[24:27], v[144:147], v[156:159], v[24:27]
    v_mfma_f32_16x16x32_bf16 v[28:31], v[148:151], v[156:159], v[28:31]
    s_waitcnt lgkmcnt(2)
    v_mfma_f32_16x16x32_bf16 v[24:27], v[164:167], v[176:179], v[24:27]
    v_mfma_f32_16x16x32_bf16 v[28:31], v[168:171], v[176:179], v[28:31]
    s_waitcnt lgkmcnt(1)
    v_mfma_f32_16x16x32_bf16 v[32:35], v[144:147], v[160:163], v[32:35]
    v_mfma_f32_16x16x32_bf16 v[36:39], v[148:151], v[160:163], v[36:39]
    s_waitcnt lgkmcnt(0)
    v_mfma_f32_16x16x32_bf16 v[32:35], v[164:167], v[180:183], v[32:35]
    v_mfma_f32_16x16x32_bf16 v[36:39], v[168:171], v[180:183], v[36:39]
    v_cvt_pk_bf16_f32 v48, v16, v17
    v_cvt_pk_bf16_f32 v49, v18, v19
    v_cvt_pk_bf16_f32 v50, v20, v21
    v_cvt_pk_bf16_f32 v51, v22, v23
    buffer_store_dwordx4 v[48:51], v5, s[24:27], s42 offen
    s_add_u32 s42, s42, 12288
    v_cvt_pk_bf16_f32 v52, v24, v25
    v_cvt_pk_bf16_f32 v53, v26, v27
    v_cvt_pk_bf16_f32 v54, v28, v29
    v_cvt_pk_bf16_f32 v55, v30, v31
    buffer_store_dwordx4 v[52:55], v5, s[24:27], s42 offen
    s_add_u32 s42, s42, 12288
    v_cvt_pk_bf16_f32 v56, v32, v33
    v_cvt_pk_bf16_f32 v57, v34, v35
    v_cvt_pk_bf16_f32 v58, v36, v37
    v_cvt_pk_bf16_f32 v59, v38, v39
    buffer_store_dwordx4 v[56:59], v5, s[24:27], s42 offen
    s_add_u32 s42, s42, 12288
    s_mov_b32 s45, 0x80000
n1_chk:
    s_waitcnt vmcnt(3)
    v_readfirstlane_b32 s46, v6
    v_readfirstlane_b32 s47, v7
    s_nop 0
    s_cmp_lg_u64 s[46:47], 0
    s_cbranch_scc0 n1_again
n1_ok:
    s_add_u32 s42, s46, s41
    s_add_u32 s42, s42, 1
    v_mov_b32 v62, s42
    v_mov_b32 v63, s47
    s_waitcnt vmcnt(0)
    s_barrier
    s_mov_b32 exec_hi, 0
    s_cmp_lg_u32 s3, 0
    s_cbranch_scc1 norep
    buffer_store_dwordx2 v[62:63], v61, s[24:27], s55 offen
norep:
    s_mov_b32 exec_lo, 1
    buffer_store_dwordx2 v[62:63], off, s[24:27], s43
    s_mov_b64 exec, -1
    s_xor_b32 s97, s32, 1
    s_add_u32 s96, s33, 1
    s_cmp_eq_u32 s96, 3
    s_cselect_b32 s96, 0, s96
    s_add_u32 s98, s96, 1
    s_cmp_eq_u32 s98, 3
    s_cselect_b32 s98, 0, s98
    v_add_u32 v11, 0, v0
    v_mul_u32_u24 v12, 5462, v11
    v_lshrrev_b32 v12, 16, v12
    v_mul_u32_u24 v13, 12, v12
    v_sub_u32 v13, v11, v13
    v_lshrrev_b32 v14, 2, v12
    v_and_b32 v14, 2, v14
    v_xor_b32 v13, v13, v14
    v_mul_u32_u24 v12, 384, v12
    v_lshl_add_u32 v200, v13, 4, v12
    v_add_u32 v11, 64, v0
    v_mul_u32_u24 v12, 5462, v11
    v_lshrrev_b32 v12, 16, v12
    v_mul_u32_u24 v13, 12, v12
    v_sub_u32 v13, v11, v13
    v_lshrrev_b32 v14, 2, v12
    v_and_b32 v14, 2, v14
    v_xor_b32 v13, v13, v14
    v_mul_u32_u24 v12, 384, v12
    v_lshl_add_u32 v201, v13, 4, v12
    v_add_u32 v11, 128, v0
    v_mul_u32_u24 v12, 5462, v11
    v_lshrrev_b32 v12, 16, v12
    v_mul_u32_u24 v13, 12, v12
    v_sub_u32 v13, v11, v13
    v_lshrrev_b32 v14, 2, v12
    v_and_b32 v14, 2, v14
    v_xor_b32 v13, v13, v14
    v_mul_u32_u24 v12, 384, v12
    v_lshl_add_u32 v202, v13, 4, v12
    s_and_b32 s36, s3, 1
    v_lshrrev_b32 v13, 2, v1
    v_lshl_add_u32 v13, v2, 3, v13
    v_mul_u32_u24 v13, 192, v13
    v_add_u32 v13, 86912, v13
    s_mul_i32 s44, s36, 96
    v_and_b32 v14, 3, v1
    v_lshlrev_b32 v14, 3, v14
    v_add_u32 v14, s44, v14
    v_and_b32 v60, 1, v2
    v_lshlrev_b32 v60, 5, v60
    v_xor_b32 v11, v14, v60
    v_add_u32 v11, v11, v13
    v_add_u32 v14, 32, v14
    v_xor_b32 v12, v14, v60
    v_add_u32 v12, v12, v13
    s_mul_i32 s44, s3, 3072
    s_add_u32 s44, s44, 123776
    v_and_b32 v13, 1, v1
    v_lshlrev_b32 v13, 3, v13
    v_lshrrev_b32 v14, 1, v1
    v_add_u32 v13, v13, v14
    v_lshl_add_u32 v13, v2, 4, v13
    v_lshlrev_b32 v13, 4, v13
    v_add_u32 v206, s44, v13
    v_add_u32 v207, s44, v5
    v_lshrrev_b32 v13, 3, v1
    v_mul_u32_u24 v13, 6144, v13
    v_and_b32 v14, 7, v1
    v_lshl_add_u32 v14, v14, 4, v13
    v_lshl_add_u32 v14, v2, 8, v14
    s_mul_i32 s44, s36, 48
    s_mul_i32 s46, s32, 96
    s_add_u32 s44, s44, s46
    s_lshl_b32 s45, s33, 1
    s_lshr_b32 s46, s3, 1
    s_add_u32 s45, s45, s46
    s_lshl_b32 s45, s45, 10
    s_add_u32 s45, s45, 73728
    s_lshr_b32 s46, s44, 5
    s_mul_i32 s48, s46, 12288
    s_and_b32 s49, s44, 31
    s_lshl_b32 s49, s49, 3
    s_add_u32 s48, s48, s49
    s_add_u32 s48, s48, s45
    v_add_u32 v203, s48, v14
    s_add_u32 s44, s44, 16
    s_lshr_b32 s46, s44, 5
    s_mul_i32 s48, s46, 12288
    s_and_b32 s49, s44, 31
    s_lshl_b32 s49, s49, 3
    s_add_u32 s48, s48, s49
    s_add_u32 s48, s48, s45
    v_add_u32 v204, s48, v14
    s_add_u32 s44, s44, 16
    s_lshr_b32 s46, s44, 5
    s_mul_i32 s48, s46, 12288
    s_and_b32 s49, s44, 31
    s_lshl_b32 s49, s49, 3
    s_add_u32 s48, s48, s49
    s_add_u32 s48, s48, s45
    v_add_u32 v205, s48, v14
    s_add_u32 s44, s44, 16
    s_mul_i32 s48, s3, 6144
    s_mul_i32 s36, s32, 192
    s_add_u32 s48, s48, s36
    s_mul_i32 s44, s3, 3072
    s_mul_i32 s45, s54, 3072
    s_add_u32 s45, s45, s39
    s_add_u32 s45, s45, 73728
    v_min_u32 v61, 23, v0
    v_lshlrev_b32 v61, 7, v61
    buffer_load_dword v61, v61, s[24:27], s45 offen
    s_mul_i32 s45, s32, 36864
    s_add_u32 s45, s45, s34
    s_mul_i32 s58, s32, 12416
    s_add_u32 s58, s58, s37
    s_add_u32 m0, s58, 62080
    s_nop 0
    buffer_load_dwordx4 v8, s[16:19], s45 offen offset:0 lds
    s_add_u32 m0, s58, 62976
    s_nop 0
    buffer_load_dwordx4 v8, s[16:19], s45 offen offset:128 lds
    s_add_u32 m0, s58, 63872
    s_nop 0
    buffer_load_dwordx4 v8, s[16:19], s45 offen offset:256 lds
    s_mul_i32 s45, s33, 24576
    s_add_u32 s45, s45, s48
    s_mul_i32 s58, s33, 12288
    s_add_u32 s58, s58, s44
    s_add_u32 m0, s58, 86912
    s_nop 0
    buffer_load_dwordx4 v200, s[20:23], s45 offen lds
    s_add_u32 m0, s58, 87936
    s_nop 0
    buffer_load_dwordx4 v201, s[20:23], s45 offen lds
    s_add_u32 m0, s58, 88960
    s_nop 0
    buffer_load_dwordx4 v202, s[20:23], s45 offen lds
    s_mul_i32 s45, s96, 24576
    s_add_u32 s45, s45, s48
    s_mul_i32 s58, s96, 12288
    s_add_u32 s58, s58, s44
    s_add_u32 m0, s58, 86912
    s_nop 0
    buffer_load_dwordx4 v200, s[20:23], s45 offen lds
    s_add_u32 m0, s58, 87936
    s_nop 0
    buffer_load_dwordx4 v201, s[20:23], s45 offen lds
    s_add_u32 m0, s58, 88960
    s_nop 0
    buffer_load_dwordx4 v202, s[20:23], s45 offen lds
    s_mul_i32 s45, s97, 36864
    s_add_u32 s45, s45, s34
    s_mul_i32 s58, s97, 12416
    s_add_u32 s58, s58, s37
    s_add_u32 m0, s58, 62080
    s_nop 0
    buffer_load_dwordx4 v8, s[16:19], s45 offen offset:0 lds
    s_add_u32 m0, s58, 62976
    s_nop 0
    buffer_load_dwordx4 v8, s[16:19], s45 offen offset:128 lds
    s_add_u32 m0, s58, 63872
    s_nop 0
    buffer_load_dwordx4 v8, s[16:19], s45 offen offset:256 lds
    s_mul_i32 s45, s98, 24576
    s_add_u32 s45, s45, s48
    s_mul_i32 s58, s98, 12288
    s_add_u32 s58, s58, s44
    s_add_u32 m0, s58, 86912
    s_nop 0
    buffer_load_dwordx4 v200, s[20:23], s45 offen lds
    s_add_u32 m0, s58, 87936
    s_nop 0
    buffer_load_dwordx4 v201, s[20:23], s45 offen lds
    s_add_u32 m0, s58, 88960
    s_nop 0
    buffer_load_dwordx4 v202, s[20:23], s45 offen lds
    s_waitcnt vmcnt(0)
    s_barrier
    ds_read_b64_tr_b16 v[82:83], v11 offset:832
    ds_read_b64_tr_b16 v[80:81], v11 offset:64
    ds_read_b64_tr_b16 v[78:79], v12 offset:768
    ds_read_b64_tr_b16 v[76:77], v12 offset:0
    ds_read_b64_tr_b16 v[74:75], v11 offset:768
    ds_read_b64_tr_b16 v[72:73], v11 offset:0
    ds_read_b128 v[68:71], v4 offset:62592
    ds_read_b128 v[64:67], v4 offset:62080
    ds_read_b64_tr_b16 v[102:103], v11 offset:6976
    ds_read_b64_tr_b16 v[100:101], v11 offset:6208
    ds_read_b64_tr_b16 v[98:99], v12 offset:6912
    ds_read_b64_tr_b16 v[96:97], v12 offset:6144
    ds_read_b64_tr_b16 v[94:95], v11 offset:6912
    ds_read_b64_tr_b16 v[92:93], v11 offset:6144
    s_waitcnt lgkmcnt(6)
    v_mfma_f32_16x16x32_bf16 v[16:19], v[64:67], v[72:75], 0
    ds_read_b128 v[88:91], v4 offset:62656
    ds_read_b128 v[84:87], v4 offset:62144
    v_mfma_f32_16x16x32_bf16 v[20:23], v[68:71], v[72:75], 0
    ds_read_b64_tr_b16 v[122:123], v11 offset:13120
    v_mfma_f32_16x16x32_bf16 v[24:27], v[64:67], v[76:79], 0
    ds_read_b64_tr_b16 v[120:121], v11 offset:12352
    v_mfma_f32_16x16x32_bf16 v[28:31], v[68:71], v[76:79], 0
    ds_read_b64_tr_b16 v[118:119], v12 offset:13056
    ds_read_b64_tr_b16 v[116:117], v12 offset:12288
    v_mfma_f32_16x16x32_bf16 v[32:35], v[64:67], v[80:83], 0
    ds_read_b64_tr_b16 v[114:115], v11 offset:13056
    v_mfma_f32_16x16x32_bf16 v[36:39], v[68:71], v[80:83], 0
    ds_read_b64_tr_b16 v[112:113], v11 offset:12288
    s_waitcnt lgkmcnt(6)
    v_mfma_f32_16x16x32_bf16 v[16:19], v[84:87], v[92:95], v[16:19]
    ds_read_b128 v[108:111], v4 offset:63616
    ds_read_b128 v[104:107], v4 offset:63104
    v_mfma_f32_16x16x32_bf16 v[20:23], v[88:91], v[92:95], v[20:23]
    ds_read_b64_tr_b16 v[142:143], v11 offset:19264
    v_mfma_f32_16x16x32_bf16 v[24:27], v[84:87], v[96:99], v[24:27]
    ds_read_b64_tr_b16 v[140:141], v11 offset:18496
    v_mfma_f32_16x16x32_bf16 v[28:31], v[88:91], v[96:99], v[28:31]
    ds_read_b64_tr_b16 v[138:139], v12 offset:19200
    ds_read_b64_tr_b16 v[136:137], v12 offset:18432
    v_mfma_f32_16x16x32_bf16 v[32:35], v[84:87], v[100:103], v[32:35]
    ds_read_b64_tr_b16 v[134:135], v11 offset:19200
    v_mfma_f32_16x16x32_bf16 v[36:39], v[88:91], v[100:103], v[36:39]
    ds_read_b64_tr_b16 v[132:133], v11 offset:18432
    s_waitcnt lgkmcnt(6)
    v_mfma_f32_16x16x32_bf16 v[16:19], v[104:107], v[112:115], v[16:19]
    ds_read_b128 v[128:131], v4 offset:63680
    ds_read_b128 v[124:127], v4 offset:63168
    v_mfma_f32_16x16x32_bf16 v[20:23], v[108:111], v[112:115], v[20:23]
    ds_read_b64_tr_b16 v[162:163], v11 offset:25408
    v_mfma_f32_16x16x32_bf16 v[24:27], v[104:107], v[116:119], v[24:27]
    ds_read_b64_tr_b16 v[160:161], v11 offset:24640
    v_mfma_f32_16x16x32_bf16 v[28:31], v[108:111], v[116:119], v[28:31]
    ds_read_b64_tr_b16 v[158:159], v12 offset:25344
    ds_read_b64_tr_b16 v[156:157], v12 offset:24576
    v_mfma_f32_16x16x32_bf16 v[32:35], v[104:107], v[120:123], v[32:35]
    ds_read_b64_tr_b16 v[154:155], v11 offset:25344
    v_mfma_f32_16x16x32_bf16 v[36:39], v[108:111], v[120:123], v[36:39]
    ds_read_b64_tr_b16 v[152:153], v11 offset:24576
    s_waitcnt lgkmcnt(6)
    v_mfma_f32_16x16x32_bf16 v[16:19], v[124:127], v[132:135], v[16:19]
    ds_read_b128 v[148:151], v4 offset:64640
    ds_read_b128 v[144:147], v4 offset:64128
    v_mfma_f32_16x16x32_bf16 v[20:23], v[128:131], v[132:135], v[20:23]
    ds_read_b64_tr_b16 v[182:183], v11 offset:31552
    v_mfma_f32_16x16x32_bf16 v[24:27], v[124:127], v[136:139], v[24:27]
    ds_read_b64_tr_b16 v[180:181], v11 offset:30784
    v_mfma_f32_16x16x32_bf16 v[28:31], v[128:131], v[136:139], v[28:31]
    ds_read_b64_tr_b16 v[178:179], v12 offset:31488
    ds_read_b64_tr_b16 v[176:177], v12 offset:30720
    v_mfma_f32_16x16x32_bf16 v[32:35], v[124:127], v[140:143], v[32:35]
    ds_read_b64_tr_b16 v[174:175], v11 offset:31488
    v_mfma_f32_16x16x32_bf16 v[36:39], v[128:131], v[140:143], v[36:39]
    ds_read_b64_tr_b16 v[172:173], v11 offset:30720
    s_waitcnt lgkmcnt(6)
    v_mfma_f32_16x16x32_bf16 v[16:19], v[144:147], v[152:155], v[16:19]
    ds_read_b128 v[168:171], v4 offset:64704
    ds_read_b128 v[164:167], v4 offset:64192
    v_mfma_f32_16x16x32_bf16 v[20:23], v[148:151], v[152:155], v[20:23]
    v_mfma_f32_16x16x32_bf16 v[24:27], v[144:147], v[156:159], v[24:27]
    v_mfma_f32_16x16x32_bf16 v[28:31], v[148:151], v[156:159], v[28:31]
    v_mfma_f32_16x16x32_bf16 v[32:35], v[144:147], v[160:163], v[32:35]
    v_mfma_f32_16x16x32_bf16 v[36:39], v[148:151], v[160:163], v[36:39]
    s_waitcnt lgkmcnt(0)
    v_mfma_f32_16x16x32_bf16 v[16:19], v[164:167], v[172:175], v[16:19]
    v_mfma_f32_16x16x32_bf16 v[20:23], v[168:171], v[172:175], v[20:23]
    v_mfma_f32_16x16x32_bf16 v[24:27], v[164:167], v[176:179], v[24:27]
    v_mfma_f32_16x16x32_bf16 v[28:31], v[168:171], v[176:179], v[28:31]
    v_mfma_f32_16x16x32_bf16 v[32:35], v[164:167], v[180:183], v[32:35]
    v_mfma_f32_16x16x32_bf16 v[36:39], v[168:171], v[180:183], v[36:39]
    s_nop 2
    v_cvt_pk_bf16_f32 v184, v16, v17
    v_cvt_pk_bf16_f32 v185, v18, v19
    v_cvt_pk_bf16_f32 v186, v20, v21
    v_cvt_pk_bf16_f32 v187, v22, v23
    ds_write_b128 v206, v[184:187] offset:0
    ds_read_b128 v[208:211], v207 offset:0
    v_cvt_pk_bf16_f32 v188, v24, v25
    v_cvt_pk_bf16_f32 v189, v26, v27
    v_cvt_pk_bf16_f32 v190, v28, v29
    v_cvt_pk_bf16_f32 v191, v30, v31
    ds_write_b128 v206, v[188:191] offset:1024
    ds_read_b128 v[212:215], v207 offset:1024
    v_cvt_pk_bf16_f32 v192, v32, v33
    v_cvt_pk_bf16_f32 v193, v34, v35
    v_cvt_pk_bf16_f32 v194, v36, v37
    v_cvt_pk_bf16_f32 v195, v38, v39
    ds_write_b128 v206, v[192:195] offset:2048
    ds_read_b128 v[216:219], v207 offset:2048
    s_waitcnt lgkmcnt(4)
    buffer_store_dwordx4 v[208:211], v203, s[24:27], s39 offen
    s_waitcnt lgkmcnt(2)
    buffer_store_dwordx4 v[212:215], v204, s[24:27], s39 offen
    s_waitcnt lgkmcnt(0)
    buffer_store_dwordx4 v[216:219], v205, s[24:27], s39 offen
    s_waitcnt vmcnt(0)
    s_mov_b64 exec, 1
    buffer_store_dwordx2 v[62:63], off, s[24:27], s43 offset:256
    s_mov_b64 exec, -1
    s_cmp_lg_u32 s53, 7
    s_cbranch_scc1 done
    buffer_store_dwordx4 v[48:51], v5, s[24:27], s40 offen sc0 sc1
    s_add_u32 s40, s40, 12288
    buffer_store_dwordx4 v[52:55], v5, s[24:27], s40 offen sc0 sc1
    s_add_u32 s40, s40, 12288
    buffer_store_dwordx4 v[56:59], v5, s[24:27], s40 offen sc0 sc1
    s_add_u32 s40, s40, 12288
    buffer_store_dwordx4 v[208:211], v203, s[24:27], 0 offen sc0 sc1
    buffer_store_dwordx4 v[212:215], v204, s[24:27], 0 offen sc0 sc1
    buffer_store_dwordx4 v[216:219], v205, s[24:27], 0 offen sc0 sc1
    s_waitcnt vmcnt(0)
    s_lshl_b32 s40, s54, 7
    s_add_u32 s40, s40, 262144
    s_mov_b64 exec, 1
    buffer_store_dwordx2 v[6:7], off, s[24:27], s40 sc0 sc1
    s_endpgm
n1_again:
    s_sub_u32 s45, s45, 1
    s_cbranch_scc1 n1_ok
    buffer_load_dwordx2 v[6:7], off, s[28:31], 0 offset:128 sc1
    s_waitcnt vmcnt(0)
    s_branch n1_chk
cons2:
    s_add_u32 s36, s32, 688128
    s_add_u32 s37, s33, 688128
    s_add_u32 s38, s34, 688128
    s_add_u32 s39, s35, 688128
    s_lshl_b32 s48, s48, 2
    s_add_u32 s48, s48, s3
    v_lshlrev_b32 v2, 4, v0
    v_add_u32 v3, 0x10000, v2
    s_mul_i32 s40, s52, 12288
    s_add_u32 s40, s40, 73728
    v_add_u32 v4, s40, v2
    v_and_b32 v5, 15, v0
    v_lshrrev_b32 v6, 4, v0
    v_lshrrev_b32 v7, 5, v0
    v_mul_u32_u24 v1, 86016, v7
    v_and_b32 v7, 1, v6
    v_mul_u32_u24 v7, 1536, v7
    v_add_u32 v1, v1, v7
    v_lshl_add_u32 v1, v5, 2, v1
    s_lshl_b32 s40, s52, 6
    v_add_u32 v1, s40, v1
    v_add_u32 v13, 688128, v1
    v_and_b32 v7, 7, v5
    v_mul_u32_u24 v8, 384, v7
    v_and_b32 v7, 2, v5
    v_xor_b32 v7, v7, v6
    v_lshl_add_u32 v8, v7, 4, v8
    v_add_u32 v8, s49, v8
    v_lshrrev_b32 v7, 3, v5
    v_mul_u32_u24 v9, 3136, v7
    v_add_u32 v9, v8, v9
    s_mul_i32 s40, s52, 45056
    s_sub_u32 s40, 22528, s40
    v_add_u32 v10, s40, v9
    v_mul_u32_u24 v248, 15680, v7
    v_sub_u32 v248, v8, v248
    v_add_u32 v248, 18816, v248
    v_add_u32 v249, s40, v248
    s_lshl_b32 s40, s3, 12
    v_add_u32 v56, s40, v2
    v_xor_b32 v57, 0x1000, v56
    v_add_u32 v250, 147456, v56
    v_add_u32 v251, 147456, v57
    s_mul_i32 s40, s52, 688128
    s_add_u32 s30, s32, 344064
    s_sub_u32 s30, s30, s40
    s_add_u32 s31, s30, 172032
    s_mov_b32 s20, s10
    s_and_b32 s21, s11, 0xffff
    s_mov_b32 s22, 19267584
    s_mov_b32 s23, 0x20000
    s_mov_b32 s24, s14
    s_and_b32 s25, s15, 0xffff
    s_mov_b32 s26, 1736704
    s_mov_b32 s27, 0x20000
    s_mov_b32 s29, 0x3dd53b95
    s_getreg_b32 s55, hwreg(HW_REG_XCC_ID, 0, 4)
    v_lshlrev_b32 v63, 7, v0
    v_add_u32 v63, done-standalone__swin_window_attn__vision_kernel-8064, v63
    s_add_u32 s46, s54, 148480
    s_add_u32 s56, s14, s46
    s_addc_u32 s57, s15, 0
    v_min_u32 v11, 23, v0
    v_lshlrev_b32 v11, 3, v11
    v_add_u32 v11, s54, v11
    v_add_u32 v11, 147712, v11
    s_mul_i32 s44, s3, 3072
    s_mul_i32 s52, s3, 9216
    s_add_u32 s52, s52, 73728
    s_waitcnt vmcnt(10)
    s_mov_b32 s40, 0
snonce:
    s_load_dwordx2 s[46:47], s[12:13], s40
    s_add_u32 s40, s40, 64
    s_waitcnt lgkmcnt(0)
    s_cmp_lg_u64 s[46:47], 0
    s_cbranch_scc1 sgot
    s_cmp_lt_u32 s40, 256
    s_cbranch_scc1 snonce
    s_branch slowm
sgot:
    s_add_u32 s42, s46, s55
    s_add_u32 s42, s42, 1
    s_mov_b32 s43, s47
    s_mov_b32 s40, 0
    s_mov_b32 s41, s54
sflag:
    s_cmp_ge_u32 s40, 2048
    s_cbranch_scc1 slowm
    s_load_dwordx8 s[92:99], s[56:57], s40
    s_add_u32 s58, s40, 32
    s_load_dwordx4 s[8:11], s[56:57], s58
    s_add_u32 s40, s40, 64
    s_waitcnt lgkmcnt(0)
    s_xor_b64 s[92:93], s[92:93], s[42:43]
    s_xor_b64 s[94:95], s[94:95], s[42:43]
    s_xor_b64 s[96:97], s[96:97], s[42:43]
    s_xor_b64 s[98:99], s[98:99], s[42:43]
    s_xor_b64 s[8:9], s[8:9], s[42:43]
    s_xor_b64 s[10:11], s[10:11], s[42:43]
    s_or_b64 s[92:93], s[92:93], s[94:95]
    s_or_b64 s[92:93], s[92:93], s[96:97]
    s_or_b64 s[92:93], s[92:93], s[98:99]
    s_or_b64 s[92:93], s[92:93], s[8:9]
    s_or_b64 s[92:93], s[92:93], s[10:11]
    s_cbranch_scc1 sflag
mok:
    v_add_u32 v12, s41, v2
    s_add_u32 m0, s44, 0
    s_nop 0
    buffer_load_dwordx4 v12, s[24:27], m0 offen offset:0 sc1 lds
    buffer_load_dwordx4 v12, s[24:27], m0 offen offset:1024 sc1 lds
    buffer_load_dwordx4 v12, s[24:27], m0 offen offset:2048 sc1 lds
    s_add_u32 m0, s44, 12288
    s_nop 0
    buffer_load_dwordx4 v12, s[24:27], m0 offen offset:0 sc1 lds
    buffer_load_dwordx4 v12, s[24:27], m0 offen offset:1024 sc1 lds
    buffer_load_dwordx4 v12, s[24:27], m0 offen offset:2048 sc1 lds
    s_add_u32 m0, s44, 24576
    s_nop 0
    buffer_load_dwordx4 v12, s[24:27], m0 offen offset:0 sc1 lds
    buffer_load_dwordx4 v12, s[24:27], m0 offen offset:1024 sc1 lds
    buffer_load_dwordx4 v12, s[24:27], m0 offen offset:2048 sc1 lds
    s_add_u32 m0, s44, 36864
    s_nop 0
    buffer_load_dwordx4 v12, s[24:27], m0 offen offset:0 sc1 lds
    buffer_load_dwordx4 v12, s[24:27], m0 offen offset:1024 sc1 lds
    buffer_load_dwordx4 v12, s[24:27], m0 offen offset:2048 sc1 lds
    s_waitcnt vmcnt(12)
    ds_read_b128 a[0:3], v9 offset:0
    ds_read_b128 a[4:7], v9 offset:64
    ds_read_b128 a[8:11], v9 offset:128
    ds_read_b128 a[12:15], v9 offset:192
    ds_read_b128 a[16:19], v9 offset:256
    ds_read_b128 a[20:23], v9 offset:320
    ds_read_b128 a[24:27], v9 offset:6272
    ds_read_b128 a[28:31], v9 offset:6336
    ds_read_b128 a[32:35], v9 offset:6400
    ds_read_b128 a[36:39], v9 offset:6464
    ds_read_b128 a[40:43], v9 offset:6528
    ds_read_b128 a[44:47], v9 offset:6592
    s_waitcnt vmcnt(6)
    s_barrier
    ds_read_b128 a[196:199], v2 offset:1024
    ds_read_b128 a[192:195], v2 offset:0
    ds_read_b128 a[204:207], v2 offset:3072
    ds_read_b128 a[200:203], v2 offset:2048
    ds_read_b128 a[212:215], v2 offset:5120
    ds_read_b128 a[208:211], v2 offset:4096
    s_waitcnt lgkmcnt(4)
    v_mfma_f32_16x16x32_bf16 v[16:19], a[192:195], a[0:3], 0
    ds_read_b128 a[220:223], v2 offset:7168
    ds_read_b128 a[216:219], v2 offset:6144
    v_mfma_f32_16x16x32_bf16 v[20:23], a[192:195], a[24:27], 0
    s_add_u32 m0, s44, 49152
    v_mfma_f32_16x16x32_bf16 v[24:27], a[196:199], a[0:3], 0
    ds_read_b128 a[48:51], v10 offset:0
    v_mfma_f32_16x16x32_bf16 v[28:31], a[196:199], a[24:27], 0
    s_waitcnt lgkmcnt(5)
    v_mfma_f32_16x16x32_bf16 v[16:19], a[200:203], a[4:7], v[16:19]
    ds_read_b128 a[196:199], v2 offset:9216
    ds_read_b128 a[192:195], v2 offset:8192
    v_mfma_f32_16x16x32_bf16 v[20:23], a[200:203], a[28:31], v[20:23]
    buffer_load_dwordx4 v12, s[24:27], m0 offen offset:0 sc1 lds
    v_mfma_f32_16x16x32_bf16 v[24:27], a[204:207], a[4:7], v[24:27]
    ds_read_b128 a[72:75], v10 offset:6272
    v_mfma_f32_16x16x32_bf16 v[28:31], a[204:207], a[28:31], v[28:31]
    s_waitcnt lgkmcnt(6)
    v_mfma_f32_16x16x32_bf16 v[16:19], a[208:211], a[8:11], v[16:19]
    ds_read_b128 a[204:207], v2 offset:11264
    ds_read_b128 a[200:203], v2 offset:10240
    v_mfma_f32_16x16x32_bf16 v[20:23], a[208:211], a[32:35], v[20:23]
    buffer_load_dwordx4 v12, s[24:27], m0 offen offset:1024 sc1 lds
    v_mfma_f32_16x16x32_bf16 v[24:27], a[212:215], a[8:11], v[24:27]
    ds_read_b128 a[52:55], v10 offset:64
    v_mfma_f32_16x16x32_bf16 v[28:31], a[212:215], a[32:35], v[28:31]
    s_waitcnt lgkmcnt(7)
    v_mfma_f32_16x16x32_bf16 v[16:19], a[216:219], a[12:15], v[16:19]
    ds_read_b128 a[212:215], v2 offset:13312
    ds_read_b128 a[208:211], v2 offset:12288
    v_mfma_f32_16x16x32_bf16 v[20:23], a[216:219], a[36:39], v[20:23]
    buffer_load_dwordx4 v12, s[24:27], m0 offen offset:2048 sc1 lds
    v_mfma_f32_16x16x32_bf16 v[24:27], a[220:223], a[12:15], v[24:27]
    s_add_u32 m0, s44, 61440
    v_mfma_f32_16x16x32_bf16 v[28:31], a[220:223], a[36:39], v[28:31]
    s_waitcnt lgkmcnt(6)
    v_mfma_f32_16x16x32_bf16 v[16:19], a[192:195], a[16:19], v[16:19]
    ds_read_b128 a[220:223], v2 offset:15360
    ds_read_b128 a[216:219], v2 offset:14336
    v_mfma_f32_16x16x32_bf16 v[20:23], a[192:195], a[40:43], v[20:23]
    buffer_load_dwordx4 v12, s[24:27], m0 offen offset:0 sc1 lds
    v_mfma_f32_16x16x32_bf16 v[24:27], a[196:199], a[16:19], v[24:27]
    ds_read_b128 a[56:59], v10 offset:128
    v_mfma_f32_16x16x32_bf16 v[28:31], a[196:199], a[40:43], v[28:31]
    s_waitcnt lgkmcnt(6)
    v_mfma_f32_16x16x32_bf16 v[16:19], a[200:203], a[20:23], v[16:19]
    ds_read_b128 a[196:199], v2 offset:17408
    ds_read_b128 a[192:195], v2 offset:16384
    v_mfma_f32_16x16x32_bf16 v[20:23], a[200:203], a[44:47], v[20:23]
    buffer_load_dwordx4 v12, s[24:27], m0 offen offset:1024 sc1 lds
    v_mfma_f32_16x16x32_bf16 v[24:27], a[204:207], a[20:23], v[24:27]
    ds_read_b128 a[60:63], v10 offset:192
    v_mfma_f32_16x16x32_bf16 v[28:31], a[204:207], a[44:47], v[28:31]
    s_waitcnt lgkmcnt(6)
    v_mfma_f32_16x16x32_bf16 v[32:35], a[208:211], a[0:3], 0
    ds_read_b128 a[204:207], v2 offset:19456
    ds_read_b128 a[200:203], v2 offset:18432
    v_mfma_f32_16x16x32_bf16 v[36:39], a[208:211], a[24:27], 0
    buffer_load_dwordx4 v12, s[24:27], m0 offen offset:2048 sc1 lds
    v_mfma_f32_16x16x32_bf16 v[40:43], a[212:215], a[0:3], 0
    s_add_u32 m0, s49, 12544
    v_mfma_f32_16x16x32_bf16 v[44:47], a[212:215], a[24:27], 0
    s_waitcnt lgkmcnt(6)
    v_mfma_f32_16x16x32_bf16 v[32:35], a[216:219], a[4:7], v[32:35]
    ds_read_b128 a[212:215], v2 offset:21504
    ds_read_b128 a[208:211], v2 offset:20480
    v_mfma_f32_16x16x32_bf16 v[36:39], a[216:219], a[28:31], v[36:39]
    ds_read_b128 a[64:67], v10 offset:256
    v_mfma_f32_16x16x32_bf16 v[40:43], a[220:223], a[4:7], v[40:43]
    v_cvt_pk_bf16_f32 v48, v16, v17
    v_cvt_pk_bf16_f32 v49, v18, v19
    v_mfma_f32_16x16x32_bf16 v[44:47], a[220:223], a[28:31], v[44:47]
    s_waitcnt lgkmcnt(6)
    v_cvt_pk_bf16_f32 v50, v24, v25
    v_cvt_pk_bf16_f32 v51, v26, v27
    v_mfma_f32_16x16x32_bf16 v[32:35], a[192:195], a[8:11], v[32:35]
    ds_read_b128 a[220:223], v2 offset:23552
    ds_read_b128 a[216:219], v2 offset:22528
    v_mfma_f32_16x16x32_bf16 v[36:39], a[192:195], a[32:35], v[36:39]
    buffer_load_dwordx4 v252, s[16:19], s36 offen offset:0 nt lds
    v_cvt_pk_bf16_f32 v52, v20, v21
    v_mfma_f32_16x16x32_bf16 v[40:43], a[196:199], a[8:11], v[40:43]
    ds_read_b128 a[68:71], v10 offset:320
    v_cvt_pk_bf16_f32 v53, v22, v23
    v_mfma_f32_16x16x32_bf16 v[44:47], a[196:199], a[32:35], v[44:47]
    s_waitcnt vmcnt(7)
    s_barrier
    s_waitcnt lgkmcnt(6)
    v_cvt_pk_bf16_f32 v54, v28, v29
    v_mfma_f32_16x16x32_bf16 v[32:35], a[200:203], a[12:15], v[32:35]
    ds_read_b128 a[196:199], v2 offset:25600
    ds_read_b128 a[192:195], v2 offset:24576
    v_mfma_f32_16x16x32_bf16 v[36:39], a[200:203], a[36:39], v[36:39]
    ds_read_b128 a[76:79], v10 offset:6336
    v_cvt_pk_bf16_f32 v55, v30, v31
    v_mfma_f32_16x16x32_bf16 v[40:43], a[204:207], a[12:15], v[40:43]
    v_mfma_f32_16x16x32_bf16 v[44:47], a[204:207], a[36:39], v[44:47]
    s_waitcnt lgkmcnt(7)
    v_mfma_f32_16x16x32_bf16 v[32:35], a[208:211], a[16:19], v[32:35]
    ds_read_b128 a[204:207], v2 offset:27648
    ds_read_b128 a[200:203], v2 offset:26624
    v_mfma_f32_16x16x32_bf16 v[36:39], a[208:211], a[40:43], v[36:39]
    buffer_load_dwordx4 v253, s[16:19], s36 offen offset:1024 nt lds
    v_mfma_f32_16x16x32_bf16 v[40:43], a[212:215], a[16:19], v[40:43]
    ds_read_b128 a[80:83], v10 offset:6400
    v_mfma_f32_16x16x32_bf16 v[44:47], a[212:215], a[40:43], v[44:47]
    s_waitcnt lgkmcnt(7)
    v_mfma_f32_16x16x32_bf16 v[32:35], a[216:219], a[20:23], v[32:35]
    ds_read_b128 a[212:215], v2 offset:29696
    ds_read_b128 a[208:211], v2 offset:28672
    v_mfma_f32_16x16x32_bf16 v[36:39], a[216:219], a[44:47], v[36:39]
    ds_read_b128 a[84:87], v10 offset:6464
    v_mfma_f32_16x16x32_bf16 v[40:43], a[220:223], a[20:23], v[40:43]
    v_mfma_f32_16x16x32_bf16 v[44:47], a[220:223], a[44:47], v[44:47]
    v_mfma_f32_16x16x32_bf16 v[64:67], a[0:3], v[48:51], 0
    buffer_load_dwordx4 v254, s[16:19], s36 offen offset:2048 nt lds
    v_mfma_f32_16x16x32_bf16 v[80:83], a[0:3], v[52:55], 0
    s_add_u32 m0, s49, 15680
    v_mfma_f32_16x16x32_bf16 v[68:71], a[24:27], v[48:51], 0
    ds_read_b128 a[88:91], v10 offset:6528
    v_mfma_f32_16x16x32_bf16 v[84:87], a[24:27], v[52:55], 0
    v_mfma_f32_16x16x32_bf16 v[72:75], a[48:51], v[48:51], 0
    ds_read_b128 a[92:95], v10 offset:6592
    v_mfma_f32_16x16x32_bf16 v[88:91], a[48:51], v[52:55], 0
    v_mfma_f32_16x16x32_bf16 v[76:79], a[72:75], v[48:51], 0
    buffer_load_dwordx4 v252, s[16:19], s37 offen offset:0 nt lds
    v_mfma_f32_16x16x32_bf16 v[92:95], a[72:75], v[52:55], 0
    s_waitcnt lgkmcnt(11)
    s_barrier
    s_waitcnt lgkmcnt(9)
    v_mfma_f32_16x16x32_bf16 v[16:19], a[192:195], a[0:3], 0
    ds_read_b128 a[220:223], v2 offset:31744
    ds_read_b128 a[216:219], v2 offset:30720
    v_mfma_f32_16x16x32_bf16 v[20:23], a[192:195], a[24:27], 0
    v_mfma_f32_16x16x32_bf16 v[24:27], a[196:199], a[0:3], 0
    v_cvt_pk_bf16_f32 v48, v32, v33
    v_cvt_pk_bf16_f32 v49, v34, v35
    v_mfma_f32_16x16x32_bf16 v[28:31], a[196:199], a[24:27], 0
    s_waitcnt lgkmcnt(8)
    v_cvt_pk_bf16_f32 v50, v40, v41
    v_cvt_pk_bf16_f32 v51, v42, v43
    v_mfma_f32_16x16x32_bf16 v[16:19], a[200:203], a[4:7], v[16:19]
    ds_read_b128 a[196:199], v2 offset:33792
    ds_read_b128 a[192:195], v2 offset:32768
    v_mfma_f32_16x16x32_bf16 v[20:23], a[200:203], a[28:31], v[20:23]
    buffer_load_dwordx4 v253, s[16:19], s37 offen offset:1024 nt lds
    v_cvt_pk_bf16_f32 v52, v36, v37
    v_mfma_f32_16x16x32_bf16 v[24:27], a[204:207], a[4:7], v[24:27]
    v_cvt_pk_bf16_f32 v53, v38, v39
    v_cvt_pk_bf16_f32 v54, v44, v45
    v_mfma_f32_16x16x32_bf16 v[28:31], a[204:207], a[28:31], v[28:31]
    s_waitcnt lgkmcnt(7)
    v_cvt_pk_bf16_f32 v55, v46, v47
    v_mfma_f32_16x16x32_bf16 v[16:19], a[208:211], a[8:11], v[16:19]
    ds_read_b128 a[204:207], v2 offset:35840
    ds_read_b128 a[200:203], v2 offset:34816
    v_mfma_f32_16x16x32_bf16 v[20:23], a[208:211], a[32:35], v[20:23]
    v_mfma_f32_16x16x32_bf16 v[24:27], a[212:215], a[8:11], v[24:27]
    v_mfma_f32_16x16x32_bf16 v[28:31], a[212:215], a[32:35], v[28:31]
    s_waitcnt lgkmcnt(4)
    v_mfma_f32_16x16x32_bf16 v[16:19], a[216:219], a[12:15], v[16:19]
    ds_read_b128 a[212:215], v2 offset:37888
    ds_read_b128 a[208:211], v2 offset:36864
    v_mfma_f32_16x16x32_bf16 v[20:23], a[216:219], a[36:39], v[20:23]
    buffer_load_dwordx4 v254, s[16:19], s37 offen offset:2048 nt lds
    v_mfma_f32_16x16x32_bf16 v[24:27], a[220:223], a[12:15], v[24:27]
    s_add_u32 m0, s49, 18816
    v_mfma_f32_16x16x32_bf16 v[28:31], a[220:223], a[36:39], v[28:31]
    s_waitcnt lgkmcnt(4)
    v_mfma_f32_16x16x32_bf16 v[16:19], a[192:195], a[16:19], v[16:19]
    ds_read_b128 a[220:223], v2 offset:39936
    ds_read_b128 a[216:219], v2 offset:38912
    v_mfma_f32_16x16x32_bf16 v[20:23], a[192:195], a[40:43], v[20:23]
    v_mfma_f32_16x16x32_bf16 v[24:27], a[196:199], a[16:19], v[24:27]
    v_mfma_f32_16x16x32_bf16 v[28:31], a[196:199], a[40:43], v[28:31]
    s_waitcnt lgkmcnt(4)
    v_mfma_f32_16x16x32_bf16 v[16:19], a[200:203], a[20:23], v[16:19]
    ds_read_b128 a[196:199], v2 offset:41984
    ds_read_b128 a[192:195], v2 offset:40960
    v_mfma_f32_16x16x32_bf16 v[20:23], a[200:203], a[44:47], v[20:23]
    buffer_load_dwordx4 v252, s[16:19], s38 offen offset:0 nt lds
    v_mfma_f32_16x16x32_bf16 v[24:27], a[204:207], a[20:23], v[24:27]
    v_mfma_f32_16x16x32_bf16 v[28:31], a[204:207], a[44:47], v[28:31]
    v_mfma_f32_16x16x32_bf16 v[64:67], a[4:7], v[48:51], v[64:67]
    s_mov_b64 exec, 0
    s_branch hop0
hop6:
    s_mov_b64 exec, -1
    v_mfma_f32_16x16x32_bf16 v[80:83], a[4:7], v[52:55], v[80:83]
    v_mfma_f32_16x16x32_bf16 v[68:71], a[28:31], v[48:51], v[68:71]
    v_mfma_f32_16x16x32_bf16 v[84:87], a[28:31], v[52:55], v[84:87]
    buffer_load_dwordx4 v253, s[16:19], s38 offen offset:1024 nt lds
    v_mfma_f32_16x16x32_bf16 v[72:75], a[52:55], v[48:51], v[72:75]
    v_mfma_f32_16x16x32_bf16 v[88:91], a[52:55], v[52:55], v[88:91]
    v_mfma_f32_16x16x32_bf16 v[76:79], a[76:79], v[48:51], v[76:79]
    v_mfma_f32_16x16x32_bf16 v[92:95], a[76:79], v[52:55], v[92:95]
    s_waitcnt lgkmcnt(4)
    v_mfma_f32_16x16x32_bf16 v[32:35], a[208:211], a[0:3], 0
    ds_read_b128 a[204:207], v2 offset:44032
    ds_read_b128 a[200:203], v2 offset:43008
    v_mfma_f32_16x16x32_bf16 v[36:39], a[208:211], a[24:27], 0
    buffer_load_dwordx4 v254, s[16:19], s38 offen offset:2048 nt lds
    v_mfma_f32_16x16x32_bf16 v[40:43], a[212:215], a[0:3], 0
    s_add_u32 m0, s49, 3136
    v_cvt_pk_bf16_f32 v48, v16, v17
    v_cvt_pk_bf16_f32 v49, v18, v19
    v_mfma_f32_16x16x32_bf16 v[44:47], a[212:215], a[24:27], 0
    s_waitcnt lgkmcnt(4)
    v_cvt_pk_bf16_f32 v50, v24, v25
    v_cvt_pk_bf16_f32 v51, v26, v27
    v_mfma_f32_16x16x32_bf16 v[32:35], a[216:219], a[4:7], v[32:35]
    ds_read_b128 a[212:215], v2 offset:46080
    ds_read_b128 a[208:211], v2 offset:45056
    v_mfma_f32_16x16x32_bf16 v[36:39], a[216:219], a[28:31], v[36:39]
    v_cvt_pk_bf16_f32 v52, v20, v21
    v_cvt_pk_bf16_f32 v53, v22, v23
    v_mfma_f32_16x16x32_bf16 v[40:43], a[220:223], a[4:7], v[40:43]
    v_cvt_pk_bf16_f32 v54, v28, v29
    v_cvt_pk_bf16_f32 v55, v30, v31
    v_mfma_f32_16x16x32_bf16 v[44:47], a[220:223], a[28:31], v[44:47]
    s_waitcnt lgkmcnt(4)
    v_mfma_f32_16x16x32_bf16 v[32:35], a[192:195], a[8:11], v[32:35]
    ds_read_b128 a[220:223], v2 offset:48128
    ds_read_b128 a[216:219], v2 offset:47104
    v_mfma_f32_16x16x32_bf16 v[36:39], a[192:195], a[32:35], v[36:39]
    buffer_load_dwordx4 v252, s[16:19], s39 offen offset:0 nt lds
    v_mfma_f32_16x16x32_bf16 v[40:43], a[196:199], a[8:11], v[40:43]
    v_mfma_f32_16x16x32_bf16 v[44:47], a[196:199], a[32:35], v[44:47]
    s_waitcnt vmcnt(10)
    s_barrier
    s_waitcnt lgkmcnt(4)
    v_mfma_f32_16x16x32_bf16 v[32:35], a[200:203], a[12:15], v[32:35]
    ds_read_b128 a[196:199], v2 offset:50176
    ds_read_b128 a[192:195], v2 offset:49152
    v_mfma_f32_16x16x32_bf16 v[36:39], a[200:203], a[36:39], v[36:39]
    v_mfma_f32_16x16x32_bf16 v[40:43], a[204:207], a[12:15], v[40:43]
    v_mfma_f32_16x16x32_bf16 v[44:47], a[204:207], a[36:39], v[44:47]
    s_waitcnt lgkmcnt(4)
    v_mfma_f32_16x16x32_bf16 v[32:35], a[208:211], a[16:19], v[32:35]
    ds_read_b128 a[204:207], v2 offset:52224
    ds_read_b128 a[200:203], v2 offset:51200
    v_mfma_f32_16x16x32_bf16 v[36:39], a[208:211], a[40:43], v[36:39]
    buffer_load_dwordx4 v253, s[16:19], s39 offen offset:1024 nt lds
    v_mfma_f32_16x16x32_bf16 v[40:43], a[212:215], a[16:19], v[40:43]
    v_mfma_f32_16x16x32_bf16 v[44:47], a[212:215], a[40:43], v[44:47]
    s_waitcnt lgkmcnt(4)
    v_mfma_f32_16x16x32_bf16 v[32:35], a[216:219], a[20:23], v[32:35]
    ds_read_b128 a[212:215], v2 offset:54272
    ds_read_b128 a[208:211], v2 offset:53248
    v_mfma_f32_16x16x32_bf16 v[36:39], a[216:219], a[44:47], v[36:39]
    v_mfma_f32_16x16x32_bf16 v[40:43], a[220:223], a[20:23], v[40:43]
    v_mfma_f32_16x16x32_bf16 v[44:47], a[220:223], a[44:47], v[44:47]
    v_mfma_f32_16x16x32_bf16 v[64:67], a[8:11], v[48:51], v[64:67]
    buffer_load_dwordx4 v254, s[16:19], s39 offen offset:2048 nt lds
    v_mfma_f32_16x16x32_bf16 v[80:83], a[8:11], v[52:55], v[80:83]
    v_mfma_f32_16x16x32_bf16 v[68:71], a[32:35], v[48:51], v[68:71]
    v_mfma_f32_16x16x32_bf16 v[84:87], a[32:35], v[52:55], v[84:87]
    v_mfma_f32_16x16x32_bf16 v[72:75], a[56:59], v[48:51], v[72:75]
    v_mfma_f32_16x16x32_bf16 v[88:91], a[56:59], v[52:55], v[88:91]
    v_mfma_f32_16x16x32_bf16 v[76:79], a[80:83], v[48:51], v[76:79]
    v_mfma_f32_16x16x32_bf16 v[92:95], a[80:83], v[52:55], v[92:95]
    s_waitcnt lgkmcnt(4)
    v_mfma_f32_16x16x32_bf16 v[16:19], a[192:195], a[0:3], 0
    ds_read_b128 a[220:223], v2 offset:56320
    ds_read_b128 a[216:219], v2 offset:55296
    v_mfma_f32_16x16x32_bf16 v[20:23], a[192:195], a[24:27], 0
    v_mfma_f32_16x16x32_bf16 v[24:27], a[196:199], a[0:3], 0
    v_cvt_pk_bf16_f32 v48, v32, v33
    v_cvt_pk_bf16_f32 v49, v34, v35
    v_mfma_f32_16x16x32_bf16 v[28:31], a[196:199], a[24:27], 0
    s_waitcnt lgkmcnt(4)
    v_cvt_pk_bf16_f32 v50, v40, v41
    v_cvt_pk_bf16_f32 v51, v42, v43
    v_mfma_f32_16x16x32_bf16 v[16:19], a[200:203], a[4:7], v[16:19]
    ds_read_b128 a[196:199], v2 offset:58368
    ds_read_b128 a[192:195], v2 offset:57344
    v_mfma_f32_16x16x32_bf16 v[20:23], a[200:203], a[28:31], v[20:23]
    v_cvt_pk_bf16_f32 v52, v36, v37
    v_cvt_pk_bf16_f32 v53, v38, v39
    v_mfma_f32_16x16x32_bf16 v[24:27], a[204:207], a[4:7], v[24:27]
    v_cvt_pk_bf16_f32 v54, v44, v45
    v_cvt_pk_bf16_f32 v55, v46, v47
    v_mfma_f32_16x16x32_bf16 v[28:31], a[204:207], a[28:31], v[28:31]
    s_waitcnt lgkmcnt(4)
    v_mfma_f32_16x16x32_bf16 v[16:19], a[208:211], a[8:11], v[16:19]
    ds_read_b128 a[204:207], v2 offset:60416
    ds_read_b128 a[200:203], v2 offset:59392
    v_mfma_f32_16x16x32_bf16 v[20:23], a[208:211], a[32:35], v[20:23]
    v_mfma_f32_16x16x32_bf16 v[24:27], a[212:215], a[8:11], v[24:27]
    v_mfma_f32_16x16x32_bf16 v[28:31], a[212:215], a[32:35], v[28:31]
    s_waitcnt lgkmcnt(4)
    v_mfma_f32_16x16x32_bf16 v[16:19], a[216:219], a[12:15], v[16:19]
    ds_read_b128 a[212:215], v2 offset:62464
    ds_read_b128 a[208:211], v2 offset:61440
    v_mfma_f32_16x16x32_bf16 v[20:23], a[216:219], a[36:39], v[20:23]
    v_mfma_f32_16x16x32_bf16 v[24:27], a[220:223], a[12:15], v[24:27]
    v_mfma_f32_16x16x32_bf16 v[28:31], a[220:223], a[36:39], v[28:31]
    s_waitcnt lgkmcnt(4)
    v_mfma_f32_16x16x32_bf16 v[16:19], a[192:195], a[16:19], v[16:19]
    ds_read_b128 a[220:223], v2 offset:64512
    ds_read_b128 a[216:219], v2 offset:63488
    v_mfma_f32_16x16x32_bf16 v[20:23], a[192:195], a[40:43], v[20:23]
    v_mfma_f32_16x16x32_bf16 v[24:27], a[196:199], a[16:19], v[24:27]
    v_mfma_f32_16x16x32_bf16 v[28:31], a[196:199], a[40:43], v[28:31]
    s_waitcnt lgkmcnt(4)
    v_mfma_f32_16x16x32_bf16 v[16:19], a[200:203], a[20:23], v[16:19]
    ds_read_b128 a[196:199], v3 offset:1024
    ds_read_b128 a[192:195], v3 offset:0
    v_mfma_f32_16x16x32_bf16 v[20:23], a[200:203], a[44:47], v[20:23]
    v_mfma_f32_16x16x32_bf16 v[24:27], a[204:207], a[20:23], v[24:27]
    v_mfma_f32_16x16x32_bf16 v[28:31], a[204:207], a[44:47], v[28:31]
    v_mfma_f32_16x16x32_bf16 v[64:67], a[12:15], v[48:51], v[64:67]
    v_mfma_f32_16x16x32_bf16 v[80:83], a[12:15], v[52:55], v[80:83]
    v_mfma_f32_16x16x32_bf16 v[68:71], a[36:39], v[48:51], v[68:71]
    v_mfma_f32_16x16x32_bf16 v[84:87], a[36:39], v[52:55], v[84:87]
    v_mfma_f32_16x16x32_bf16 v[72:75], a[60:63], v[48:51], v[72:75]
    v_mfma_f32_16x16x32_bf16 v[88:91], a[60:63], v[52:55], v[88:91]
    v_mfma_f32_16x16x32_bf16 v[76:79], a[84:87], v[48:51], v[76:79]
    v_mfma_f32_16x16x32_bf16 v[92:95], a[84:87], v[52:55], v[92:95]
    s_waitcnt lgkmcnt(4)
    v_mfma_f32_16x16x32_bf16 v[32:35], a[208:211], a[0:3], 0
    ds_read_b128 a[204:207], v3 offset:3072
    ds_read_b128 a[200:203], v3 offset:2048
    v_mfma_f32_16x16x32_bf16 v[36:39], a[208:211], a[24:27], 0
    v_mfma_f32_16x16x32_bf16 v[40:43], a[212:215], a[0:3], 0
    s_waitcnt vmcnt(6)
    v_cvt_pk_bf16_f32 v48, v16, v17
    v_cvt_pk_bf16_f32 v49, v18, v19
    v_mfma_f32_16x16x32_bf16 v[44:47], a[212:215], a[24:27], 0
    s_waitcnt lgkmcnt(4)
    v_cvt_pk_bf16_f32 v50, v24, v25
    v_cvt_pk_bf16_f32 v51, v26, v27
    v_mfma_f32_16x16x32_bf16 v[32:35], a[216:219], a[4:7], v[32:35]
    ds_read_b128 a[212:215], v3 offset:5120
    ds_read_b128 a[208:211], v3 offset:4096
    v_mfma_f32_16x16x32_bf16 v[36:39], a[216:219], a[28:31], v[36:39]
    ds_read_b128 a[96:99], v9 offset:12544
    v_cvt_pk_bf16_f32 v52, v20, v21
    v_mfma_f32_16x16x32_bf16 v[40:43], a[220:223], a[4:7], v[40:43]
    v_cvt_pk_bf16_f32 v53, v22, v23
    v_cvt_pk_bf16_f32 v54, v28, v29
    v_mfma_f32_16x16x32_bf16 v[44:47], a[220:223], a[28:31], v[44:47]
    s_waitcnt lgkmcnt(5)
    v_cvt_pk_bf16_f32 v55, v30, v31
    v_mfma_f32_16x16x32_bf16 v[32:35], a[192:195], a[8:11], v[32:35]
    ds_read_b128 a[220:223], v3 offset:7168
    ds_read_b128 a[216:219], v3 offset:6144
    v_mfma_f32_16x16x32_bf16 v[36:39], a[192:195], a[32:35], v[36:39]
    ds_read_b128 a[100:103], v9 offset:12608
    v_mfma_f32_16x16x32_bf16 v[40:43], a[196:199], a[8:11], v[40:43]
    v_mfma_f32_16x16x32_bf16 v[44:47], a[196:199], a[32:35], v[44:47]
    s_waitcnt lgkmcnt(6)
    v_mfma_f32_16x16x32_bf16 v[32:35], a[200:203], a[12:15], v[32:35]
    ds_read_b128 a[196:199], v2 offset:1024
    ds_read_b128 a[192:195], v2 offset:0
    v_mfma_f32_16x16x32_bf16 v[36:39], a[200:203], a[36:39], v[36:39]
    ds_read_b128 a[104:107], v9 offset:12672
    v_mfma_f32_16x16x32_bf16 v[40:43], a[204:207], a[12:15], v[40:43]
    v_mfma_f32_16x16x32_bf16 v[44:47], a[204:207], a[36:39], v[44:47]
    s_waitcnt lgkmcnt(7)
    v_mfma_f32_16x16x32_bf16 v[32:35], a[208:211], a[16:19], v[32:35]
    ds_read_b128 a[204:207], v2 offset:3072
    ds_read_b128 a[200:203], v2 offset:2048
    v_mfma_f32_16x16x32_bf16 v[36:39], a[208:211], a[40:43], v[36:39]
    ds_read_b128 a[108:111], v9 offset:12736
    v_mfma_f32_16x16x32_bf16 v[40:43], a[212:215], a[16:19], v[40:43]
    v_mfma_f32_16x16x32_bf16 v[44:47], a[212:215], a[40:43], v[44:47]
    s_waitcnt lgkmcnt(7)
    v_mfma_f32_16x16x32_bf16 v[32:35], a[216:219], a[20:23], v[32:35]
    ds_read_b128 a[212:215], v2 offset:5120
    ds_read_b128 a[208:211], v2 offset:4096
    v_mfma_f32_16x16x32_bf16 v[36:39], a[216:219], a[44:47], v[36:39]
    ds_read_b128 a[112:115], v9 offset:12800
    v_mfma_f32_16x16x32_bf16 v[40:43], a[220:223], a[20:23], v[40:43]
    v_mfma_f32_16x16x32_bf16 v[44:47], a[220:223], a[44:47], v[44:47]
    v_mfma_f32_16x16x32_bf16 v[64:67], a[16:19], v[48:51], v[64:67]
    ds_read_b128 a[116:119], v9 offset:12864
    v_mfma_f32_16x16x32_bf16 v[80:83], a[16:19], v[52:55], v[80:83]
    s_waitcnt vmcnt(0)
    v_mfma_f32_16x16x32_bf16 v[68:71], a[40:43], v[48:51], v[68:71]
    ds_read_b128 a[120:123], v248 offset:0
    v_mfma_f32_16x16x32_bf16 v[84:87], a[40:43], v[52:55], v[84:87]
    ds_read_b128 a[124:127], v248 offset:64
    v_mfma_f32_16x16x32_bf16 v[72:75], a[64:67], v[48:51], v[72:75]
    ds_read_b128 a[128:131], v248 offset:128
    v_mfma_f32_16x16x32_bf16 v[88:91], a[64:67], v[52:55], v[88:91]
    ds_read_b128 a[132:135], v248 offset:192
    v_mfma_f32_16x16x32_bf16 v[76:79], a[88:91], v[48:51], v[76:79]
    ds_read_b128 a[136:139], v248 offset:256
    v_mfma_f32_16x16x32_bf16 v[92:95], a[88:91], v[52:55], v[92:95]
    s_waitcnt lgkmcnt(13)
    v_mfma_f32_16x16x32_bf16 v[16:19], a[192:195], a[96:99], 0
    ds_read_b128 a[220:223], v2 offset:7168
    ds_read_b128 a[216:219], v2 offset:6144
    s_waitcnt lgkmcnt(6)
    v_mfma_f32_16x16x32_bf16 v[20:23], a[192:195], a[120:123], 0
    ds_read_b128 a[140:143], v248 offset:320
    v_mfma_f32_16x16x32_bf16 v[24:27], a[196:199], a[96:99], 0
    v_cvt_pk_bf16_f32 v48, v32, v33
    v_cvt_pk_bf16_f32 v49, v34, v35
    v_mfma_f32_16x16x32_bf16 v[28:31], a[196:199], a[120:123], 0
    v_cvt_pk_bf16_f32 v50, v40, v41
    v_cvt_pk_bf16_f32 v51, v42, v43
    v_mfma_f32_16x16x32_bf16 v[16:19], a[200:203], a[100:103], v[16:19]
hop0:
    s_cbranch_execz hop1
    ds_read_b128 a[196:199], v2 offset:9216
    ds_read_b128 a[192:195], v2 offset:8192
    s_waitcnt lgkmcnt(8)
    v_mfma_f32_16x16x32_bf16 v[20:23], a[200:203], a[124:127], v[20:23]
    v_cvt_pk_bf16_f32 v52, v36, v37
    v_cvt_pk_bf16_f32 v53, v38, v39
    v_mfma_f32_16x16x32_bf16 v[24:27], a[204:207], a[100:103], v[24:27]
    v_cvt_pk_bf16_f32 v54, v44, v45
    v_cvt_pk_bf16_f32 v55, v46, v47
    v_mfma_f32_16x16x32_bf16 v[28:31], a[204:207], a[124:127], v[28:31]
    v_mfma_f32_16x16x32_bf16 v[16:19], a[208:211], a[104:107], v[16:19]
    ds_read_b128 a[204:207], v2 offset:11264
    ds_read_b128 a[200:203], v2 offset:10240
    s_waitcnt lgkmcnt(9)
    v_mfma_f32_16x16x32_bf16 v[20:23], a[208:211], a[128:131], v[20:23]
    v_mfma_f32_16x16x32_bf16 v[24:27], a[212:215], a[104:107], v[24:27]
    v_mfma_f32_16x16x32_bf16 v[28:31], a[212:215], a[128:131], v[28:31]
    s_waitcnt lgkmcnt(5)
    v_mfma_f32_16x16x32_bf16 v[16:19], a[216:219], a[108:111], v[16:19]
    ds_read_b128 a[212:215], v2 offset:13312
    ds_read_b128 a[208:211], v2 offset:12288
    v_mfma_f32_16x16x32_bf16 v[20:23], a[216:219], a[132:135], v[20:23]
    v_mfma_f32_16x16x32_bf16 v[24:27], a[220:223], a[108:111], v[24:27]
    v_mfma_f32_16x16x32_bf16 v[28:31], a[220:223], a[132:135], v[28:31]
    v_mfma_f32_16x16x32_bf16 v[64:67], a[20:23], v[48:51], v[64:67]
    s_barrier
    v_mfma_f32_16x16x32_bf16 v[80:83], a[20:23], v[52:55], v[80:83]
    ds_read_b128 a[144:147], v10 offset:12544
    v_mfma_f32_16x16x32_bf16 v[68:71], a[44:47], v[48:51], v[68:71]
    v_mfma_f32_16x16x32_bf16 v[84:87], a[44:47], v[52:55], v[84:87]
    ds_read_b128 a[168:171], v249 offset:0
    v_mfma_f32_16x16x32_bf16 v[72:75], a[68:71], v[48:51], v[72:75]
    v_mfma_f32_16x16x32_bf16 v[88:91], a[68:71], v[52:55], v[88:91]
    ds_read_b128 a[148:151], v10 offset:12608
    v_mfma_f32_16x16x32_bf16 v[76:79], a[92:95], v[48:51], v[76:79]
    v_mfma_f32_16x16x32_bf16 v[92:95], a[92:95], v[52:55], v[92:95]
    s_waitcnt lgkmcnt(7)
    v_mfma_f32_16x16x32_bf16 v[16:19], a[192:195], a[112:115], v[16:19]
    ds_read_b128 a[220:223], v2 offset:15360
    ds_read_b128 a[216:219], v2 offset:14336
    v_mfma_f32_16x16x32_bf16 v[20:23], a[192:195], a[136:139], v[20:23]
    ds_read_b128 a[172:175], v249 offset:64
    v_mfma_f32_16x16x32_bf16 v[24:27], a[196:199], a[112:115], v[24:27]
    v_mfma_f32_16x16x32_bf16 v[28:31], a[196:199], a[136:139], v[28:31]
    s_waitcnt lgkmcnt(8)
    v_mfma_f32_16x16x32_bf16 v[16:19], a[200:203], a[116:119], v[16:19]
    ds_read_b128 a[196:199], v2 offset:17408
    ds_read_b128 a[192:195], v2 offset:16384
    v_mfma_f32_16x16x32_bf16 v[20:23], a[200:203], a[140:143], v[20:23]
    ds_read_b128 a[152:155], v10 offset:12672
    v_max3_f32 v5, v64, v65, v66
    v_mfma_f32_16x16x32_bf16 v[24:27], a[204:207], a[116:119], v[24:27]
    v_max3_f32 v5, v5, v67, v68
    v_max3_f32 v5, v5, v69, v70
    v_mfma_f32_16x16x32_bf16 v[28:31], a[204:207], a[140:143], v[28:31]
    s_waitcnt lgkmcnt(9)
    v_max3_f32 v5, v5, v71, v72
    v_max3_f32 v5, v5, v73, v74
    v_mfma_f32_16x16x32_bf16 v[32:35], a[208:211], a[96:99], 0
    ds_read_b128 a[204:207], v2 offset:19456
    ds_read_b128 a[200:203], v2 offset:18432
    v_mfma_f32_16x16x32_bf16 v[36:39], a[208:211], a[120:123], 0
    ds_read_b128 a[176:179], v249 offset:128
    v_max3_f32 v5, v5, v75, v76
    v_mfma_f32_16x16x32_bf16 v[40:43], a[212:215], a[96:99], 0
    v_max3_f32 v5, v5, v77, v78
    v_max_f32 v5, v5, v79
    v_mfma_f32_16x16x32_bf16 v[44:47], a[212:215], a[120:123], 0
    s_waitcnt lgkmcnt(7)
    v_max3_f32 v6, v80, v81, v82
    v_max3_f32 v6, v6, v83, v84
    v_mfma_f32_16x16x32_bf16 v[32:35], a[216:219], a[100:103], v[32:35]
    ds_read_b128 a[212:215], v2 offset:21504
    ds_read_b128 a[208:211], v2 offset:20480
    v_mfma_f32_16x16x32_bf16 v[36:39], a[216:219], a[124:127], v[36:39]
    ds_read_b128 a[156:159], v10 offset:12736
    v_max3_f32 v6, v6, v85, v86
    v_mfma_f32_16x16x32_bf16 v[40:43], a[220:223], a[100:103], v[40:43]
    buffer_load_dwordx2 v[14:15], v11, s[24:27], 0 offen sc1
    v_cvt_pk_bf16_f32 v48, v16, v17
    v_mfma_f32_16x16x32_bf16 v[44:47], a[220:223], a[124:127], v[44:47]
    s_waitcnt lgkmcnt(7)
    v_cvt_pk_bf16_f32 v49, v18, v19
    v_cvt_pk_bf16_f32 v50, v24, v25
    v_mfma_f32_16x16x32_bf16 v[32:35], a[192:195], a[104:107], v[32:35]
    ds_read_b128 a[220:223], v2 offset:23552
    ds_read_b128 a[216:219], v2 offset:22528
    v_mfma_f32_16x16x32_bf16 v[36:39], a[192:195], a[128:131], v[36:39]
    ds_read_b128 a[180:183], v249 offset:192
    v_cvt_pk_bf16_f32 v51, v26, v27
    v_mfma_f32_16x16x32_bf16 v[40:43], a[196:199], a[104:107], v[40:43]
    v_cvt_pk_bf16_f32 v52, v20, v21
    v_cvt_pk_bf16_f32 v53, v22, v23
    v_mfma_f32_16x16x32_bf16 v[44:47], a[196:199], a[128:131], v[44:47]
    s_waitcnt lgkmcnt(7)
    v_cvt_pk_bf16_f32 v54, v28, v29
    v_cvt_pk_bf16_f32 v55, v30, v31
    v_mfma_f32_16x16x32_bf16 v[32:35], a[200:203], a[108:111], v[32:35]
    ds_read_b128 a[196:199], v2 offset:25600
    ds_read_b128 a[192:195], v2 offset:24576
    v_mfma_f32_16x16x32_bf16 v[36:39], a[200:203], a[132:135], v[36:39]
    ds_read_b128 a[160:163], v10 offset:12800
    v_max3_f32 v6, v6, v87, v88
    v_mfma_f32_16x16x32_bf16 v[40:43], a[204:207], a[108:111], v[40:43]
    v_max3_f32 v6, v6, v89, v90
    v_max3_f32 v6, v6, v91, v92
    v_mfma_f32_16x16x32_bf16 v[44:47], a[204:207], a[132:135], v[44:47]
    s_waitcnt lgkmcnt(7)
    v_max3_f32 v6, v6, v93, v94
    v_max_f32 v6, v6, v95
    v_mfma_f32_16x16x32_bf16 v[32:35], a[208:211], a[112:115], v[32:35]
    ds_read_b128 a[204:207], v2 offset:27648
    ds_read_b128 a[200:203], v2 offset:26624
    v_mfma_f32_16x16x32_bf16 v[36:39], a[208:211], a[136:139], v[36:39]
    ds_read_b128 a[184:187], v249 offset:256
    v_permlane32_swap_b32 v5, v6
    v_mfma_f32_16x16x32_bf16 v[40:43], a[212:215], a[112:115], v[40:43]
    v_max_f32 v5, v5, v6
    v_mov_b32 v6, v5
    v_mfma_f32_16x16x32_bf16 v[44:47], a[212:215], a[136:139], v[44:47]
    s_waitcnt lgkmcnt(7)
    v_mfma_f32_16x16x32_bf16 v[32:35], a[216:219], a[116:119], v[32:35]
    ds_read_b128 a[212:215], v2 offset:29696
    ds_read_b128 a[208:211], v2 offset:28672
    v_mfma_f32_16x16x32_bf16 v[36:39], a[216:219], a[140:143], v[36:39]
    ds_read_b128 a[164:167], v10 offset:12864
    v_permlane16_swap_b32 v5, v6
    v_mfma_f32_16x16x32_bf16 v[40:43], a[220:223], a[116:119], v[40:43]
    v_max_f32 v5, v5, v6
    v_mul_f32 v5, s29, v5
    v_mfma_f32_16x16x32_bf16 v[44:47], a[220:223], a[140:143], v[44:47]
    v_mov_b32 v6, v5
    v_mfma_f32_16x16x32_bf16 v[96:99], a[96:99], v[48:51], 0
    ds_read_b128 a[188:191], v249 offset:320
    v_mfma_f32_16x16x32_bf16 v[112:115], a[96:99], v[52:55], 0
    v_permlane32_swap_b32 v5, v6
    v_fma_f32 v64, v64, s29, -v5
    v_mfma_f32_16x16x32_bf16 v[100:103], a[120:123], v[48:51], 0
    v_exp_f32 v64, v64
    v_mfma_f32_16x16x32_bf16 v[116:119], a[120:123], v[52:55], 0
    v_fma_f32 v65, v65, s29, -v5
    v_fma_f32 v66, v66, s29, -v5
    v_mfma_f32_16x16x32_bf16 v[104:107], a[144:147], v[48:51], 0
    v_exp_f32 v65, v65
    v_mfma_f32_16x16x32_bf16 v[120:123], a[144:147], v[52:55], 0
    v_exp_f32 v66, v66
    v_mfma_f32_16x16x32_bf16 v[108:111], a[168:171], v[48:51], 0
    v_fma_f32 v67, v67, s29, -v5
    v_fma_f32 v68, v68, s29, -v5
    v_mfma_f32_16x16x32_bf16 v[124:127], a[168:171], v[52:55], 0
    s_waitcnt lgkmcnt(8)
    v_exp_f32 v67, v67
    v_mfma_f32_16x16x32_bf16 v[16:19], a[192:195], a[96:99], 0
    ds_read_b128 a[220:223], v2 offset:31744
    ds_read_b128 a[216:219], v2 offset:30720
    v_mfma_f32_16x16x32_bf16 v[20:23], a[192:195], a[120:123], 0
    v_exp_f32 v68, v68
    v_mfma_f32_16x16x32_bf16 v[24:27], a[196:199], a[96:99], 0
    s_waitcnt vmcnt(0)
    v_cmp_eq_u64 vcc, s[42:43], v[14:15]
    v_cvt_pk_bf16_f32 v48, v32, v33
    v_mfma_f32_16x16x32_bf16 v[28:31], a[196:199], a[120:123], 0
    s_waitcnt lgkmcnt(7)
    v_cvt_pk_bf16_f32 v49, v34, v35
    v_cvt_pk_bf16_f32 v50, v40, v41
    v_mfma_f32_16x16x32_bf16 v[16:19], a[200:203], a[100:103], v[16:19]
    ds_read_b128 a[196:199], v2 offset:33792
    ds_read_b128 a[192:195], v2 offset:32768
    v_mfma_f32_16x16x32_bf16 v[20:23], a[200:203], a[124:127], v[20:23]
    s_cmp_eq_u32 vcc_lo, -1
    v_cvt_pk_bf16_f32 v51, v42, v43
    v_cvt_pk_bf16_f32 v52, v36, v37
    v_mfma_f32_16x16x32_bf16 v[24:27], a[204:207], a[100:103], v[24:27]
    s_cbranch_scc0 polln
nok:
    v_cvt_pk_bf16_f32 v53, v38, v39
    v_cvt_pk_bf16_f32 v54, v44, v45
    v_mfma_f32_16x16x32_bf16 v[28:31], a[204:207], a[124:127], v[28:31]
    s_waitcnt lgkmcnt(6)
    v_cvt_pk_bf16_f32 v55, v46, v47
    v_fma_f32 v69, v69, s29, -v5
    v_mfma_f32_16x16x32_bf16 v[16:19], a[208:211], a[104:107], v[16:19]
    ds_read_b128 a[204:207], v2 offset:35840
    ds_read_b128 a[200:203], v2 offset:34816
    v_mfma_f32_16x16x32_bf16 v[20:23], a[208:211], a[128:131], v[20:23]
    s_waitcnt lgkmcnt(6)
    s_barrier
    v_add_f32 v7, v64, v65
    v_mfma_f32_16x16x32_bf16 v[24:27], a[212:215], a[104:107], v[24:27]
    s_add_u32 m0, s52, 0
    v_exp_f32 v69, v69
    v_mfma_f32_16x16x32_bf16 v[28:31], a[212:215], a[128:131], v[28:31]
    s_waitcnt lgkmcnt(4)
    v_fma_f32 v70, v70, s29, -v5
    v_fma_f32 v71, v71, s29, -v5
    v_mfma_f32_16x16x32_bf16 v[16:19], a[216:219], a[108:111], v[16:19]
    ds_read_b128 a[212:215], v2 offset:37888
    ds_read_b128 a[208:211], v2 offset:36864
    v_mfma_f32_16x16x32_bf16 v[20:23], a[216:219], a[132:135], v[20:23]
    buffer_load_dwordx4 v12, s[24:27], m0 offen offset:0 sc1 lds
    v_add_f32 v7, v7, v66
    v_mfma_f32_16x16x32_bf16 v[24:27], a[220:223], a[108:111], v[24:27]
    v_exp_f32 v70, v70
    v_mfma_f32_16x16x32_bf16 v[28:31], a[220:223], a[132:135], v[28:31]
    s_waitcnt lgkmcnt(4)
    v_exp_f32 v71, v71
    v_mfma_f32_16x16x32_bf16 v[16:19], a[192:195], a[112:115], v[16:19]
    ds_read_b128 a[220:223], v2 offset:39936
    ds_read_b128 a[216:219], v2 offset:38912
    v_mfma_f32_16x16x32_bf16 v[20:23], a[192:195], a[136:139], v[20:23]
    buffer_load_dwordx4 v12, s[24:27], m0 offen offset:1024 sc1 lds
    v_add_f32 v7, v7, v67
    v_mfma_f32_16x16x32_bf16 v[24:27], a[196:199], a[112:115], v[24:27]
    v_fma_f32 v72, v72, s29, -v5
    v_fma_f32 v73, v73, s29, -v5
    v_mfma_f32_16x16x32_bf16 v[28:31], a[196:199], a[136:139], v[28:31]
    s_waitcnt lgkmcnt(4)
    v_exp_f32 v72, v72
    v_mfma_f32_16x16x32_bf16 v[16:19], a[200:203], a[116:119], v[16:19]
    ds_read_b128 a[196:199], v2 offset:41984
    ds_read_b128 a[192:195], v2 offset:40960
    v_mfma_f32_16x16x32_bf16 v[20:23], a[200:203], a[140:143], v[20:23]
    buffer_load_dwordx4 v12, s[24:27], m0 offen offset:2048 sc1 lds
    v_add_f32 v7, v7, v68
    v_mfma_f32_16x16x32_bf16 v[24:27], a[204:207], a[116:119], v[24:27]
    s_add_u32 m0, s52, 3072
    v_exp_f32 v73, v73
    v_mfma_f32_16x16x32_bf16 v[28:31], a[204:207], a[140:143], v[28:31]
    v_add_f32 v7, v7, v69
    v_fma_f32 v74, v74, s29, -v5
    v_mfma_f32_16x16x32_bf16 v[96:99], a[100:103], v[48:51], v[96:99]
    v_exp_f32 v74, v74
    v_mfma_f32_16x16x32_bf16 v[112:115], a[100:103], v[52:55], v[112:115]
    buffer_load_dwordx4 v12, s[24:27], m0 offen offset:0 sc1 lds
    v_fma_f32 v75, v75, s29, -v5
    v_mfma_f32_16x16x32_bf16 v[100:103], a[124:127], v[48:51], v[100:103]
    v_exp_f32 v75, v75
    v_mfma_f32_16x16x32_bf16 v[116:119], a[124:127], v[52:55], v[116:119]
    v_add_f32 v7, v7, v70
    v_add_f32 v7, v7, v71
    v_mfma_f32_16x16x32_bf16 v[104:107], a[148:151], v[48:51], v[104:107]
    v_fma_f32 v76, v76, s29, -v5
    v_fma_f32 v77, v77, s29, -v5
    v_mfma_f32_16x16x32_bf16 v[120:123], a[148:151], v[52:55], v[120:123]
    buffer_load_dwordx4 v12, s[24:27], m0 offen offset:1024 sc1 lds
    v_add_f32 v7, v7, v72
    v_mfma_f32_16x16x32_bf16 v[108:111], a[172:175], v[48:51], v[108:111]
    v_exp_f32 v76, v76
    v_mfma_f32_16x16x32_bf16 v[124:127], a[172:175], v[52:55], v[124:127]
    s_waitcnt lgkmcnt(4)
    v_exp_f32 v77, v77
    v_mfma_f32_16x16x32_bf16 v[32:35], a[208:211], a[96:99], 0
    ds_read_b128 a[204:207], v2 offset:44032
    ds_read_b128 a[200:203], v2 offset:43008
    v_mfma_f32_16x16x32_bf16 v[36:39], a[208:211], a[120:123], 0
    buffer_load_dwordx4 v12, s[24:27], m0 offen offset:2048 sc1 lds
    v_add_f32 v7, v7, v73
    v_mfma_f32_16x16x32_bf16 v[40:43], a[212:215], a[96:99], 0
    s_add_u32 m0, s52, 6144
    v_cvt_pk_bf16_f32 v48, v16, v17
    v_cvt_pk_bf16_f32 v49, v18, v19
    v_mfma_f32_16x16x32_bf16 v[44:47], a[212:215], a[120:123], 0
    s_waitcnt lgkmcnt(4)
    v_cvt_pk_bf16_f32 v50, v24, v25
    v_cvt_pk_bf16_f32 v51, v26, v27
    v_mfma_f32_16x16x32_bf16 v[32:35], a[216:219], a[100:103], v[32:35]
    ds_read_b128 a[212:215], v2 offset:46080
    ds_read_b128 a[208:211], v2 offset:45056
    v_mfma_f32_16x16x32_bf16 v[36:39], a[216:219], a[124:127], v[36:39]
    buffer_load_dwordx4 v12, s[24:27], m0 offen offset:0 sc1 lds
    v_cvt_pk_bf16_f32 v52, v20, v21
    v_mfma_f32_16x16x32_bf16 v[40:43], a[220:223], a[100:103], v[40:43]
    v_cvt_pk_bf16_f32 v53, v22, v23
    v_cvt_pk_bf16_f32 v54, v28, v29
    v_mfma_f32_16x16x32_bf16 v[44:47], a[220:223], a[124:127], v[44:47]
    s_waitcnt lgkmcnt(4)
    v_cvt_pk_bf16_f32 v55, v30, v31
    v_fma_f32 v78, v78, s29, -v5
    v_mfma_f32_16x16x32_bf16 v[32:35], a[192:195], a[104:107], v[32:35]
    ds_read_b128 a[220:223], v2 offset:48128
    ds_read_b128 a[216:219], v2 offset:47104
    v_mfma_f32_16x16x32_bf16 v[36:39], a[192:195], a[128:131], v[36:39]
    buffer_load_dwordx4 v12, s[24:27], m0 offen offset:1024 sc1 lds
    v_fma_f32 v79, v79, s29, -v5
    v_mfma_f32_16x16x32_bf16 v[40:43], a[196:199], a[104:107], v[40:43]
    v_exp_f32 v78, v78
    v_mfma_f32_16x16x32_bf16 v[44:47], a[196:199], a[128:131], v[44:47]
hop1:
    s_cbranch_execz hop2
    s_waitcnt lgkmcnt(4)
    v_exp_f32 v79, v79
    v_mfma_f32_16x16x32_bf16 v[32:35], a[200:203], a[108:111], v[32:35]
    ds_read_b128 a[196:199], v2 offset:50176
    ds_read_b128 a[192:195], v2 offset:49152
    v_mfma_f32_16x16x32_bf16 v[36:39], a[200:203], a[132:135], v[36:39]
    buffer_load_dwordx4 v12, s[24:27], m0 offen offset:2048 sc1 lds
    v_add_f32 v7, v7, v74
    v_mfma_f32_16x16x32_bf16 v[40:43], a[204:207], a[108:111], v[40:43]
    s_add_u32 m0, s52, 36864
    v_add_f32 v7, v7, v75
    v_fma_f32 v80, v80, s29, -v6
    v_mfma_f32_16x16x32_bf16 v[44:47], a[204:207], a[132:135], v[44:47]
    s_waitcnt lgkmcnt(4)
    v_exp_f32 v80, v80
    v_mfma_f32_16x16x32_bf16 v[32:35], a[208:211], a[112:115], v[32:35]
    ds_read_b128 a[204:207], v2 offset:52224
    ds_read_b128 a[200:203], v2 offset:51200
    v_mfma_f32_16x16x32_bf16 v[36:39], a[208:211], a[136:139], v[36:39]
    buffer_load_dwordx4 v12, s[24:27], m0 offen offset:0 sc1 lds
    v_fma_f32 v81, v81, s29, -v6
    v_mfma_f32_16x16x32_bf16 v[40:43], a[212:215], a[112:115], v[40:43]
    v_exp_f32 v81, v81
    v_mfma_f32_16x16x32_bf16 v[44:47], a[212:215], a[136:139], v[44:47]
    s_waitcnt lgkmcnt(4)
    v_add_f32 v7, v7, v76
    v_add_f32 v7, v7, v77
    v_mfma_f32_16x16x32_bf16 v[32:35], a[216:219], a[116:119], v[32:35]
    ds_read_b128 a[212:215], v2 offset:54272
    ds_read_b128 a[208:211], v2 offset:53248
    v_mfma_f32_16x16x32_bf16 v[36:39], a[216:219], a[140:143], v[36:39]
    buffer_load_dwordx4 v12, s[24:27], m0 offen offset:1024 sc1 lds
    v_fma_f32 v82, v82, s29, -v6
    v_mfma_f32_16x16x32_bf16 v[40:43], a[220:223], a[116:119], v[40:43]
    v_exp_f32 v82, v82
    v_mfma_f32_16x16x32_bf16 v[44:47], a[220:223], a[140:143], v[44:47]
    v_fma_f32 v83, v83, s29, -v6
    v_add_f32 v7, v7, v78
    v_mfma_f32_16x16x32_bf16 v[96:99], a[104:107], v[48:51], v[96:99]
    v_exp_f32 v83, v83
    v_mfma_f32_16x16x32_bf16 v[112:115], a[104:107], v[52:55], v[112:115]
    buffer_load_dwordx4 v12, s[24:27], m0 offen offset:2048 sc1 lds
    v_add_f32 v7, v7, v79
    v_mfma_f32_16x16x32_bf16 v[100:103], a[128:131], v[48:51], v[100:103]
    s_add_u32 m0, s52, 39936
    v_fma_f32 v84, v84, s29, -v6
    v_fma_f32 v85, v85, s29, -v6
    v_mfma_f32_16x16x32_bf16 v[116:119], a[128:131], v[52:55], v[116:119]
    v_exp_f32 v84, v84
    v_mfma_f32_16x16x32_bf16 v[104:107], a[152:155], v[48:51], v[104:107]
    v_exp_f32 v85, v85
    v_mfma_f32_16x16x32_bf16 v[120:123], a[152:155], v[52:55], v[120:123]
    buffer_load_dwordx4 v12, s[24:27], m0 offen offset:0 sc1 lds
    v_add_f32 v8, v80, v81
    v_mfma_f32_16x16x32_bf16 v[108:111], a[176:179], v[48:51], v[108:111]
    v_fma_f32 v86, v86, s29, -v6
    v_fma_f32 v87, v87, s29, -v6
    v_mfma_f32_16x16x32_bf16 v[124:127], a[176:179], v[52:55], v[124:127]
    s_waitcnt lgkmcnt(4)
    v_exp_f32 v86, v86
    v_mfma_f32_16x16x32_bf16 v[16:19], a[192:195], a[96:99], 0
    ds_read_b128 a[220:223], v2 offset:56320
    ds_read_b128 a[216:219], v2 offset:55296
    v_mfma_f32_16x16x32_bf16 v[20:23], a[192:195], a[120:123], 0
    buffer_load_dwordx4 v12, s[24:27], m0 offen offset:1024 sc1 lds
    v_add_f32 v8, v8, v82
    v_mfma_f32_16x16x32_bf16 v[24:27], a[196:199], a[96:99], 0
    v_cvt_pk_bf16_f32 v48, v32, v33
    v_cvt_pk_bf16_f32 v49, v34, v35
    v_mfma_f32_16x16x32_bf16 v[28:31], a[196:199], a[120:123], 0
    s_waitcnt lgkmcnt(4)
    v_cvt_pk_bf16_f32 v50, v40, v41
    v_cvt_pk_bf16_f32 v51, v42, v43
    v_mfma_f32_16x16x32_bf16 v[16:19], a[200:203], a[100:103], v[16:19]
    ds_read_b128 a[196:199], v2 offset:58368
    ds_read_b128 a[192:195], v2 offset:57344
    v_mfma_f32_16x16x32_bf16 v[20:23], a[200:203], a[124:127], v[20:23]
    buffer_load_dwordx4 v12, s[24:27], m0 offen offset:2048 sc1 lds
    v_cvt_pk_bf16_f32 v52, v36, v37
    v_mfma_f32_16x16x32_bf16 v[24:27], a[204:207], a[100:103], v[24:27]
    s_add_u32 m0, s52, 43008
    v_cvt_pk_bf16_f32 v53, v38, v39
    v_cvt_pk_bf16_f32 v54, v44, v45
    v_mfma_f32_16x16x32_bf16 v[28:31], a[204:207], a[124:127], v[28:31]
    s_waitcnt lgkmcnt(4)
    v_cvt_pk_bf16_f32 v55, v46, v47
    v_add_f32 v8, v8, v83
    v_mfma_f32_16x16x32_bf16 v[16:19], a[208:211], a[104:107], v[16:19]
    ds_read_b128 a[204:207], v2 offset:60416
    ds_read_b128 a[200:203], v2 offset:59392
    v_mfma_f32_16x16x32_bf16 v[20:23], a[208:211], a[128:131], v[20:23]
    buffer_load_dwordx4 v12, s[24:27], m0 offen offset:0 sc1 lds
    v_fma_f32 v88, v88, s29, -v6
    v_mfma_f32_16x16x32_bf16 v[24:27], a[212:215], a[104:107], v[24:27]
    v_exp_f32 v87, v87
    v_mfma_f32_16x16x32_bf16 v[28:31], a[212:215], a[128:131], v[28:31]
    s_waitcnt lgkmcnt(4)
    v_exp_f32 v88, v88
    v_mfma_f32_16x16x32_bf16 v[16:19], a[216:219], a[108:111], v[16:19]
    ds_read_b128 a[212:215], v2 offset:62464
    ds_read_b128 a[208:211], v2 offset:61440
    v_mfma_f32_16x16x32_bf16 v[20:23], a[216:219], a[132:135], v[20:23]
    buffer_load_dwordx4 v12, s[24:27], m0 offen offset:1024 sc1 lds
    v_fma_f32 v89, v89, s29, -v6
    v_mfma_f32_16x16x32_bf16 v[24:27], a[220:223], a[108:111], v[24:27]
    v_exp_f32 v89, v89
    v_mfma_f32_16x16x32_bf16 v[28:31], a[220:223], a[132:135], v[28:31]
    s_waitcnt lgkmcnt(4)
    v_add_f32 v8, v8, v84
    v_add_f32 v8, v8, v85
    v_mfma_f32_16x16x32_bf16 v[16:19], a[192:195], a[112:115], v[16:19]
    ds_read_b128 a[220:223], v2 offset:64512
    ds_read_b128 a[216:219], v2 offset:63488
    v_mfma_f32_16x16x32_bf16 v[20:23], a[192:195], a[136:139], v[20:23]
    buffer_load_dwordx4 v12, s[24:27], m0 offen offset:2048 sc1 lds
    v_fma_f32 v90, v90, s29, -v6
    v_mfma_f32_16x16x32_bf16 v[24:27], a[196:199], a[112:115], v[24:27]
    v_exp_f32 v90, v90
    v_mfma_f32_16x16x32_bf16 v[28:31], a[196:199], a[136:139], v[28:31]
    s_waitcnt lgkmcnt(4)
    v_fma_f32 v91, v91, s29, -v6
    v_add_f32 v8, v8, v86
    v_mfma_f32_16x16x32_bf16 v[16:19], a[200:203], a[116:119], v[16:19]
    ds_read_b128 a[196:199], v3 offset:1024
    ds_read_b128 a[192:195], v3 offset:0
    v_mfma_f32_16x16x32_bf16 v[20:23], a[200:203], a[140:143], v[20:23]
    v_exp_f32 v91, v91
    v_mfma_f32_16x16x32_bf16 v[24:27], a[204:207], a[116:119], v[24:27]
    v_add_f32 v8, v8, v87
    v_fma_f32 v92, v92, s29, -v6
    v_mfma_f32_16x16x32_bf16 v[28:31], a[204:207], a[140:143], v[28:31]
    v_exp_f32 v92, v92
    v_mfma_f32_16x16x32_bf16 v[96:99], a[108:111], v[48:51], v[96:99]
    v_fma_f32 v93, v93, s29, -v6
    v_add_f32 v8, v8, v88
    v_mfma_f32_16x16x32_bf16 v[112:115], a[108:111], v[52:55], v[112:115]
    v_exp_f32 v93, v93
    v_mfma_f32_16x16x32_bf16 v[100:103], a[132:135], v[48:51], v[100:103]
    v_add_f32 v8, v8, v89
    v_fma_f32 v94, v94, s29, -v6
    v_mfma_f32_16x16x32_bf16 v[116:119], a[132:135], v[52:55], v[116:119]
    v_exp_f32 v94, v94
    v_mfma_f32_16x16x32_bf16 v[104:107], a[156:159], v[48:51], v[104:107]
    v_fma_f32 v95, v95, s29, -v6
    v_add_f32 v8, v8, v90
    v_mfma_f32_16x16x32_bf16 v[120:123], a[156:159], v[52:55], v[120:123]
    v_exp_f32 v95, v95
    v_mfma_f32_16x16x32_bf16 v[108:111], a[180:183], v[48:51], v[108:111]
    v_add_f32 v8, v8, v91
    v_add_f32 v8, v8, v92
    v_mfma_f32_16x16x32_bf16 v[124:127], a[180:183], v[52:55], v[124:127]
    s_waitcnt lgkmcnt(4)
    v_add_f32 v8, v8, v93
    v_add_f32 v8, v8, v94
    v_mfma_f32_16x16x32_bf16 v[32:35], a[208:211], a[96:99], 0
    ds_read_b128 a[204:207], v3 offset:3072
    ds_read_b128 a[200:203], v3 offset:2048
    v_mfma_f32_16x16x32_bf16 v[36:39], a[208:211], a[120:123], 0
    v_add_f32 v8, v8, v95
    v_mfma_f32_16x16x32_bf16 v[40:43], a[212:215], a[96:99], 0
    v_cvt_pk_bf16_f32 v48, v16, v17
    v_cvt_pk_bf16_f32 v49, v18, v19
    v_mfma_f32_16x16x32_bf16 v[44:47], a[212:215], a[120:123], 0
    s_waitcnt lgkmcnt(4)
    v_cvt_pk_bf16_f32 v50, v24, v25
    v_cvt_pk_bf16_f32 v51, v26, v27
    v_mfma_f32_16x16x32_bf16 v[32:35], a[216:219], a[100:103], v[32:35]
    ds_read_b128 a[212:215], v3 offset:5120
    ds_read_b128 a[208:211], v3 offset:4096
    v_mfma_f32_16x16x32_bf16 v[36:39], a[216:219], a[124:127], v[36:39]
    v_cvt_pk_bf16_f32 v52, v20, v21
    v_cvt_pk_bf16_f32 v53, v22, v23
    v_mfma_f32_16x16x32_bf16 v[40:43], a[220:223], a[100:103], v[40:43]
    v_cvt_pk_bf16_f32 v54, v28, v29
    v_cvt_pk_bf16_f32 v55, v30, v31
    v_mfma_f32_16x16x32_bf16 v[44:47], a[220:223], a[124:127], v[44:47]
    s_waitcnt lgkmcnt(4)
    v_permlane32_swap_b32 v7, v8
    v_add_f32 v7, v7, v8
    v_mfma_f32_16x16x32_bf16 v[32:35], a[192:195], a[104:107], v[32:35]
    ds_read_b128 a[220:223], v3 offset:7168
    ds_read_b128 a[216:219], v3 offset:6144
    v_mfma_f32_16x16x32_bf16 v[36:39], a[192:195], a[128:131], v[36:39]
    v_mov_b32 v8, v7
    v_mfma_f32_16x16x32_bf16 v[40:43], a[196:199], a[104:107], v[40:43]
    s_waitcnt vmcnt(0)
    s_barrier
    v_mfma_f32_16x16x32_bf16 v[44:47], a[196:199], a[128:131], v[44:47]
    s_waitcnt lgkmcnt(4)
    v_permlane16_swap_b32 v7, v8
    v_add_f32 v7, v7, v8
    v_mfma_f32_16x16x32_bf16 v[32:35], a[200:203], a[108:111], v[32:35]
    ds_read_b128 a[196:199], v4 offset:1024
    ds_read_b128 a[192:195], v4 offset:0
    v_mfma_f32_16x16x32_bf16 v[36:39], a[200:203], a[132:135], v[36:39]
    v_rcp_f32 v7, v7
    v_mfma_f32_16x16x32_bf16 v[40:43], a[204:207], a[108:111], v[40:43]
    v_mov_b32 v8, v7
    v_mfma_f32_16x16x32_bf16 v[44:47], a[204:207], a[132:135], v[44:47]
    s_waitcnt lgkmcnt(4)
    v_mfma_f32_16x16x32_bf16 v[32:35], a[208:211], a[112:115], v[32:35]
    ds_read_b128 a[204:207], v4 offset:3072
    ds_read_b128 a[200:203], v4 offset:2048
    v_mfma_f32_16x16x32_bf16 v[36:39], a[208:211], a[136:139], v[36:39]
    v_permlane32_swap_b32 v7, v8
    v_mul_f32 v64, v7, v64
    v_mfma_f32_16x16x32_bf16 v[40:43], a[212:215], a[112:115], v[40:43]
    v_mul_f32 v65, v7, v65
    v_cvt_pk_bf16_f32 v128, v64, v65
    v_mfma_f32_16x16x32_bf16 v[44:47], a[212:215], a[136:139], v[44:47]
    s_waitcnt lgkmcnt(4)
    v_mul_f32 v66, v7, v66
    v_mul_f32 v67, v7, v67
    v_mfma_f32_16x16x32_bf16 v[32:35], a[216:219], a[116:119], v[32:35]
    ds_read_b128 a[212:215], v4 offset:5120
    ds_read_b128 a[208:211], v4 offset:4096
    v_mfma_f32_16x16x32_bf16 v[36:39], a[216:219], a[140:143], v[36:39]
    v_cvt_pk_bf16_f32 v129, v66, v67
    v_mul_f32 v68, v7, v68
    v_mfma_f32_16x16x32_bf16 v[40:43], a[220:223], a[116:119], v[40:43]
    ds_write_b64 v250, v[128:129] offset:0
    v_mfma_f32_16x16x32_bf16 v[44:47], a[220:223], a[140:143], v[44:47]
    v_mul_f32 v69, v7, v69
    v_cvt_pk_bf16_f32 v130, v68, v69
    v_mfma_f32_16x16x32_bf16 v[96:99], a[112:115], v[48:51], v[96:99]
    v_mul_f32 v70, v7, v70
    v_mul_f32 v71, v7, v71
    v_mfma_f32_16x16x32_bf16 v[112:115], a[112:115], v[52:55], v[112:115]
    v_cvt_pk_bf16_f32 v131, v70, v71
    v_mul_f32 v72, v7, v72
    v_mfma_f32_16x16x32_bf16 v[100:103], a[136:139], v[48:51], v[100:103]
    ds_write_b64 v250, v[130:131] offset:8
    v_mfma_f32_16x16x32_bf16 v[116:119], a[136:139], v[52:55], v[116:119]
    v_mul_f32 v73, v7, v73
    v_cvt_pk_bf16_f32 v132, v72, v73
    v_mfma_f32_16x16x32_bf16 v[104:107], a[160:163], v[48:51], v[104:107]
    v_mul_f32 v74, v7, v74
    v_mul_f32 v75, v7, v75
    v_mfma_f32_16x16x32_bf16 v[120:123], a[160:163], v[52:55], v[120:123]
    v_cvt_pk_bf16_f32 v133, v74, v75
    v_mul_f32 v76, v7, v76
    v_mfma_f32_16x16x32_bf16 v[108:111], a[184:187], v[48:51], v[108:111]
    ds_write_b64 v250, v[132:133] offset:1024
    v_mfma_f32_16x16x32_bf16 v[124:127], a[184:187], v[52:55], v[124:127]
    s_waitcnt lgkmcnt(7)
    v_mul_f32 v77, v7, v77
    v_cvt_pk_bf16_f32 v134, v76, v77
    v_mfma_f32_16x16x32_bf16 v[16:19], a[0:3], a[192:195], 0
    ds_read_b128 a[220:223], v4 offset:7168
    ds_read_b128 a[216:219], v4 offset:6144
    v_mfma_f32_16x16x32_bf16 v[20:23], a[24:27], a[192:195], 0
    v_mul_f32 v78, v7, v78
    v_mul_f32 v79, v7, v79
    v_mfma_f32_16x16x32_bf16 v[24:27], a[48:51], a[192:195], 0
    v_cvt_pk_bf16_f32 v48, v32, v33
    v_cvt_pk_bf16_f32 v49, v34, v35
    v_mfma_f32_16x16x32_bf16 v[28:31], a[72:75], a[192:195], 0
    v_cvt_pk_bf16_f32 v50, v40, v41
    v_cvt_pk_bf16_f32 v51, v42, v43
    v_mfma_f32_16x16x32_bf16 v[16:19], a[4:7], a[196:199], v[16:19]
    v_cvt_pk_bf16_f32 v52, v36, v37
    v_cvt_pk_bf16_f32 v53, v38, v39
    v_mfma_f32_16x16x32_bf16 v[20:23], a[28:31], a[196:199], v[20:23]
    v_cvt_pk_bf16_f32 v54, v44, v45
    v_cvt_pk_bf16_f32 v55, v46, v47
    v_mfma_f32_16x16x32_bf16 v[24:27], a[52:55], a[196:199], v[24:27]
    v_cvt_pk_bf16_f32 v135, v78, v79
    v_mul_f32 v80, v8, v80
    v_mfma_f32_16x16x32_bf16 v[28:31], a[76:79], a[196:199], v[28:31]
    s_waitcnt lgkmcnt(7)
    v_mul_f32 v81, v8, v81
    v_cvt_pk_bf16_f32 v136, v80, v81
    v_mfma_f32_16x16x32_bf16 v[16:19], a[8:11], a[200:203], v[16:19]
    ds_read_b128 a[196:199], v4 offset:9216
    ds_read_b128 a[192:195], v4 offset:8192
    v_mfma_f32_16x16x32_bf16 v[20:23], a[32:35], a[200:203], v[20:23]
    ds_write_b64 v250, v[134:135] offset:1032
    v_mfma_f32_16x16x32_bf16 v[24:27], a[56:59], a[200:203], v[24:27]
    v_mul_f32 v82, v8, v82
    v_mul_f32 v83, v8, v83
    v_mfma_f32_16x16x32_bf16 v[28:31], a[80:83], a[200:203], v[28:31]
    v_cvt_pk_bf16_f32 v137, v82, v83
    v_mul_f32 v84, v8, v84
    v_mfma_f32_16x16x32_bf16 v[96:99], a[116:119], v[48:51], v[96:99]
    ds_write_b64 v250, v[136:137] offset:2048
    v_mfma_f32_16x16x32_bf16 v[112:115], a[116:119], v[52:55], v[112:115]
    v_mul_f32 v85, v8, v85
    v_cvt_pk_bf16_f32 v138, v84, v85
    v_mfma_f32_16x16x32_bf16 v[100:103], a[140:143], v[48:51], v[100:103]
    v_mul_f32 v86, v8, v86
    v_mul_f32 v87, v8, v87
    v_mfma_f32_16x16x32_bf16 v[116:119], a[140:143], v[52:55], v[116:119]
    v_cvt_pk_bf16_f32 v139, v86, v87
    v_mul_f32 v88, v8, v88
    v_mfma_f32_16x16x32_bf16 v[104:107], a[164:167], v[48:51], v[104:107]
    ds_write_b64 v250, v[138:139] offset:2056
    v_mfma_f32_16x16x32_bf16 v[120:123], a[164:167], v[52:55], v[120:123]
    v_mul_f32 v89, v8, v89
    v_cvt_pk_bf16_f32 v140, v88, v89
    v_mfma_f32_16x16x32_bf16 v[108:111], a[188:191], v[48:51], v[108:111]
    v_mul_f32 v90, v8, v90
    v_mul_f32 v91, v8, v91
    v_mfma_f32_16x16x32_bf16 v[124:127], a[188:191], v[52:55], v[124:127]
hop2:
    s_cbranch_execz hop3
    v_cvt_pk_bf16_f32 v141, v90, v91
    v_mul_f32 v92, v8, v92
    v_mfma_f32_16x16x32_bf16 v[16:19], a[12:15], a[204:207], v[16:19]
    ds_write_b64 v250, v[140:141] offset:3072
    v_mfma_f32_16x16x32_bf16 v[20:23], a[36:39], a[204:207], v[20:23]
    v_mul_f32 v93, v8, v93
    v_cvt_pk_bf16_f32 v142, v92, v93
    v_mfma_f32_16x16x32_bf16 v[24:27], a[60:63], a[204:207], v[24:27]
    v_mul_f32 v94, v8, v94
    v_mul_f32 v95, v8, v95
    v_mfma_f32_16x16x32_bf16 v[28:31], a[84:87], a[204:207], v[28:31]
    s_waitcnt lgkmcnt(11)
    v_cvt_pk_bf16_f32 v143, v94, v95
    v_mfma_f32_16x16x32_bf16 v[16:19], a[16:19], a[208:211], v[16:19]
    ds_read_b128 a[204:207], v4 offset:11264
    ds_read_b128 a[200:203], v4 offset:10240
    v_mfma_f32_16x16x32_bf16 v[20:23], a[40:43], a[208:211], v[20:23]
    ds_write_b64 v250, v[142:143] offset:3080
    v_mfma_f32_16x16x32_bf16 v[24:27], a[64:67], a[208:211], v[24:27]
    v_max3_f32 v5, v96, v97, v98
    v_max3_f32 v5, v5, v99, v100
    v_mfma_f32_16x16x32_bf16 v[28:31], a[88:91], a[208:211], v[28:31]
    v_max3_f32 v5, v5, v101, v102
    v_max3_f32 v5, v5, v103, v104
    v_mfma_f32_16x16x32_bf16 v[16:19], a[20:23], a[212:215], v[16:19]
    v_max3_f32 v5, v5, v105, v106
    v_max3_f32 v5, v5, v107, v108
    v_mfma_f32_16x16x32_bf16 v[20:23], a[44:47], a[212:215], v[20:23]
    v_max3_f32 v5, v5, v109, v110
    v_max_f32 v5, v5, v111
    v_mfma_f32_16x16x32_bf16 v[24:27], a[68:71], a[212:215], v[24:27]
    s_waitcnt lgkmcnt(0)
    s_barrier
    v_max3_f32 v6, v112, v113, v114
    v_mfma_f32_16x16x32_bf16 v[28:31], a[92:95], a[212:215], v[28:31]
    v_max3_f32 v6, v6, v115, v116
    v_max3_f32 v6, v6, v117, v118
    v_mfma_f32_16x16x32_bf16 v[32:35], a[0:3], a[216:219], 0
    ds_read_b128 a[212:215], v4 offset:25600
    ds_read_b128 a[208:211], v4 offset:24576
    v_mfma_f32_16x16x32_bf16 v[36:39], a[24:27], a[216:219], 0
    ds_read_b128 v[148:151], v251 offset:0
    ds_read_b128 v[144:147], v251 offset:1024
    v_mfma_f32_16x16x32_bf16 v[40:43], a[48:51], a[216:219], 0
    ds_read_b128 v[156:159], v251 offset:2048
    ds_read_b128 v[152:155], v251 offset:3072
    v_mfma_f32_16x16x32_bf16 v[44:47], a[72:75], a[216:219], 0
    v_max3_f32 v6, v6, v119, v120
    v_max3_f32 v6, v6, v121, v122
    v_mfma_f32_16x16x32_bf16 v[32:35], a[4:7], a[220:223], v[32:35]
    v_max3_f32 v6, v6, v123, v124
    v_max3_f32 v6, v6, v125, v126
    v_mfma_f32_16x16x32_bf16 v[36:39], a[28:31], a[220:223], v[36:39]
    v_max_f32 v6, v6, v127
    v_mfma_f32_16x16x32_bf16 v[40:43], a[52:55], a[220:223], v[40:43]
    v_cvt_pk_bf16_f32 v192, v16, v17
    v_cvt_pk_bf16_f32 v193, v18, v19
    v_mfma_f32_16x16x32_bf16 v[44:47], a[76:79], a[220:223], v[44:47]
    v_cvt_pk_bf16_f32 v194, v20, v21
    v_cvt_pk_bf16_f32 v195, v22, v23
    v_mfma_f32_16x16x32_bf16 v[32:35], a[8:11], a[192:195], v[32:35]
    ds_read_b128 a[220:223], v4 offset:27648
    ds_read_b128 a[216:219], v4 offset:26624
    v_mfma_f32_16x16x32_bf16 v[36:39], a[32:35], a[192:195], v[36:39]
    v_cvt_pk_bf16_f32 v196, v24, v25
    v_cvt_pk_bf16_f32 v197, v26, v27
    v_mfma_f32_16x16x32_bf16 v[40:43], a[56:59], a[192:195], v[40:43]
    v_cvt_pk_bf16_f32 v198, v28, v29
    v_cvt_pk_bf16_f32 v199, v30, v31
    v_mfma_f32_16x16x32_bf16 v[44:47], a[80:83], a[192:195], v[44:47]
    v_permlane32_swap_b32 v5, v6
    v_max_f32 v5, v5, v6
    v_mfma_f32_16x16x32_bf16 v[216:219], v[128:131], v[192:195], 0
    v_mov_b32 v6, v5
    v_mfma_f32_16x16x32_bf16 v[224:227], v[136:139], v[192:195], 0
    s_waitcnt lgkmcnt(4)
    v_mfma_f32_16x16x32_bf16 v[232:235], v[144:147], v[192:195], 0
    s_waitcnt lgkmcnt(2)
    v_permlane16_swap_b32 v5, v6
    v_max_f32 v5, v5, v6
    v_mfma_f32_16x16x32_bf16 v[240:243], v[152:155], v[192:195], 0
    v_mul_f32 v5, s29, v5
    v_mov_b32 v6, v5
    v_mfma_f32_16x16x32_bf16 v[216:219], v[132:135], v[196:199], v[216:219]
    v_mfma_f32_16x16x32_bf16 v[224:227], v[140:143], v[196:199], v[224:227]
    v_permlane32_swap_b32 v5, v6
    v_fma_f32 v96, v96, s29, -v5
    v_mfma_f32_16x16x32_bf16 v[232:235], v[148:151], v[196:199], v[232:235]
    v_exp_f32 v96, v96
    v_mfma_f32_16x16x32_bf16 v[240:243], v[156:159], v[196:199], v[240:243]
    v_fma_f32 v97, v97, s29, -v5
    v_fma_f32 v98, v98, s29, -v5
    v_mfma_f32_16x16x32_bf16 v[32:35], a[12:15], a[196:199], v[32:35]
    v_exp_f32 v97, v97
    v_mfma_f32_16x16x32_bf16 v[36:39], a[36:39], a[196:199], v[36:39]
    v_exp_f32 v98, v98
    v_mfma_f32_16x16x32_bf16 v[40:43], a[60:63], a[196:199], v[40:43]
    v_fma_f32 v99, v99, s29, -v5
    v_fma_f32 v100, v100, s29, -v5
    v_mfma_f32_16x16x32_bf16 v[44:47], a[84:87], a[196:199], v[44:47]
    v_exp_f32 v99, v99
    v_mfma_f32_16x16x32_bf16 v[32:35], a[16:19], a[200:203], v[32:35]
    ds_read_b128 a[196:199], v4 offset:29696
    ds_read_b128 a[192:195], v4 offset:28672
    v_mfma_f32_16x16x32_bf16 v[36:39], a[40:43], a[200:203], v[36:39]
    v_exp_f32 v100, v100
    v_mfma_f32_16x16x32_bf16 v[40:43], a[64:67], a[200:203], v[40:43]
    v_fma_f32 v101, v101, s29, -v5
    v_add_f32 v7, v96, v97
    v_mfma_f32_16x16x32_bf16 v[44:47], a[88:91], a[200:203], v[44:47]
    v_exp_f32 v101, v101
    v_mfma_f32_16x16x32_bf16 v[32:35], a[20:23], a[204:207], v[32:35]
    v_fma_f32 v102, v102, s29, -v5
    v_fma_f32 v103, v103, s29, -v5
    v_mfma_f32_16x16x32_bf16 v[36:39], a[44:47], a[204:207], v[36:39]
    v_exp_f32 v102, v102
    v_mfma_f32_16x16x32_bf16 v[40:43], a[68:71], a[204:207], v[40:43]
    v_exp_f32 v103, v103
    v_mfma_f32_16x16x32_bf16 v[44:47], a[92:95], a[204:207], v[44:47]
    v_add_f32 v7, v7, v98
    v_add_f32 v7, v7, v99
    v_mfma_f32_16x16x32_bf16 v[16:19], a[0:3], a[208:211], 0
    ds_read_b128 a[204:207], v4 offset:31744
    ds_read_b128 a[200:203], v4 offset:30720
    v_mfma_f32_16x16x32_bf16 v[20:23], a[24:27], a[208:211], 0
    v_fma_f32 v104, v104, s29, -v5
    v_fma_f32 v105, v105, s29, -v5
    v_mfma_f32_16x16x32_bf16 v[24:27], a[48:51], a[208:211], 0
    v_exp_f32 v104, v104
    v_mfma_f32_16x16x32_bf16 v[28:31], a[72:75], a[208:211], 0
    v_exp_f32 v105, v105
    v_mfma_f32_16x16x32_bf16 v[16:19], a[4:7], a[212:215], v[16:19]
    v_add_f32 v7, v7, v100
    v_add_f32 v7, v7, v101
    v_mfma_f32_16x16x32_bf16 v[20:23], a[28:31], a[212:215], v[20:23]
    v_fma_f32 v106, v106, s29, -v5
    v_fma_f32 v107, v107, s29, -v5
    v_mfma_f32_16x16x32_bf16 v[24:27], a[52:55], a[212:215], v[24:27]
    v_cvt_pk_bf16_f32 v200, v32, v33
    v_cvt_pk_bf16_f32 v201, v34, v35
    v_mfma_f32_16x16x32_bf16 v[28:31], a[76:79], a[212:215], v[28:31]
    s_waitcnt lgkmcnt(4)
    v_cvt_pk_bf16_f32 v202, v36, v37
    v_cvt_pk_bf16_f32 v203, v38, v39
    v_mfma_f32_16x16x32_bf16 v[16:19], a[8:11], a[216:219], v[16:19]
    ds_read_b128 a[212:215], v4 offset:33792
    ds_read_b128 a[208:211], v4 offset:32768
    v_mfma_f32_16x16x32_bf16 v[20:23], a[32:35], a[216:219], v[20:23]
    v_cvt_pk_bf16_f32 v204, v40, v41
    v_cvt_pk_bf16_f32 v205, v42, v43
    v_mfma_f32_16x16x32_bf16 v[24:27], a[56:59], a[216:219], v[24:27]
    v_cvt_pk_bf16_f32 v206, v44, v45
    v_cvt_pk_bf16_f32 v207, v46, v47
    v_mfma_f32_16x16x32_bf16 v[28:31], a[80:83], a[216:219], v[28:31]
    v_exp_f32 v106, v106
    v_mfma_f32_16x16x32_bf16 v[220:223], v[128:131], v[200:203], 0
    v_exp_f32 v107, v107
    v_mfma_f32_16x16x32_bf16 v[228:231], v[136:139], v[200:203], 0
    v_add_f32 v7, v7, v102
    v_add_f32 v7, v7, v103
    v_mfma_f32_16x16x32_bf16 v[236:239], v[144:147], v[200:203], 0
    v_fma_f32 v108, v108, s29, -v5
    v_fma_f32 v109, v109, s29, -v5
    v_mfma_f32_16x16x32_bf16 v[244:247], v[152:155], v[200:203], 0
    v_exp_f32 v108, v108
    v_mfma_f32_16x16x32_bf16 v[220:223], v[132:135], v[204:207], v[220:223]
    v_exp_f32 v109, v109
    v_mfma_f32_16x16x32_bf16 v[228:231], v[140:143], v[204:207], v[228:231]
    v_add_f32 v7, v7, v104
    v_add_f32 v7, v7, v105
    v_mfma_f32_16x16x32_bf16 v[236:239], v[148:151], v[204:207], v[236:239]
    v_fma_f32 v110, v110, s29, -v5
    v_fma_f32 v111, v111, s29, -v5
    v_mfma_f32_16x16x32_bf16 v[244:247], v[156:159], v[204:207], v[244:247]
    v_exp_f32 v110, v110
    v_mfma_f32_16x16x32_bf16 v[16:19], a[12:15], a[220:223], v[16:19]
    v_exp_f32 v111, v111
    v_mfma_f32_16x16x32_bf16 v[20:23], a[36:39], a[220:223], v[20:23]
    v_add_f32 v7, v7, v106
    v_add_f32 v7, v7, v107
    v_mfma_f32_16x16x32_bf16 v[24:27], a[60:63], a[220:223], v[24:27]
    v_fma_f32 v112, v112, s29, -v6
    v_fma_f32 v113, v113, s29, -v6
    v_mfma_f32_16x16x32_bf16 v[28:31], a[84:87], a[220:223], v[28:31]
    s_waitcnt lgkmcnt(4)
    v_exp_f32 v112, v112
    v_mfma_f32_16x16x32_bf16 v[16:19], a[16:19], a[192:195], v[16:19]
    ds_read_b128 a[220:223], v4 offset:35840
    ds_read_b128 a[216:219], v4 offset:34816
    v_mfma_f32_16x16x32_bf16 v[20:23], a[40:43], a[192:195], v[20:23]
    v_cvt_pk_bf16_f32 v58, v216, v220
    v_cvt_pk_bf16_f32 v59, v217, v221
    v_mfma_f32_16x16x32_bf16 v[24:27], a[64:67], a[192:195], v[24:27]
    buffer_store_dword v58, v1, s[20:23], s32 offen offset:0 sc1
    v_mfma_f32_16x16x32_bf16 v[28:31], a[88:91], a[192:195], v[28:31]
    v_cvt_pk_bf16_f32 v60, v218, v222
    v_add_f32 v7, v7, v108
    v_mfma_f32_16x16x32_bf16 v[16:19], a[20:23], a[196:199], v[16:19]
    buffer_store_dword v59, v1, s[20:23], s32 offen offset:384 sc1
    v_mfma_f32_16x16x32_bf16 v[20:23], a[44:47], a[196:199], v[20:23]
    v_exp_f32 v113, v113
    v_mfma_f32_16x16x32_bf16 v[24:27], a[68:71], a[196:199], v[24:27]
    v_cvt_pk_bf16_f32 v61, v219, v223
    v_add_f32 v7, v7, v109
    v_mfma_f32_16x16x32_bf16 v[28:31], a[92:95], a[196:199], v[28:31]
    s_waitcnt lgkmcnt(4)
    v_fma_f32 v114, v114, s29, -v6
    v_fma_f32 v115, v115, s29, -v6
    v_mfma_f32_16x16x32_bf16 v[32:35], a[0:3], a[200:203], 0
    ds_read_b128 a[196:199], v4 offset:50176
    ds_read_b128 a[192:195], v4 offset:49152
    v_mfma_f32_16x16x32_bf16 v[36:39], a[24:27], a[200:203], 0
    buffer_store_dword v60, v1, s[20:23], s32 offen offset:768 sc1
    v_mfma_f32_16x16x32_bf16 v[40:43], a[48:51], a[200:203], 0
    v_cvt_pk_bf16_f32 v58, v224, v228
    v_add_f32 v7, v7, v110
    v_mfma_f32_16x16x32_bf16 v[44:47], a[72:75], a[200:203], 0
    v_exp_f32 v114, v114
    v_mfma_f32_16x16x32_bf16 v[32:35], a[4:7], a[204:207], v[32:35]
    buffer_store_dword v61, v1, s[20:23], s32 offen offset:1152 sc1
    v_mfma_f32_16x16x32_bf16 v[36:39], a[28:31], a[204:207], v[36:39]
    v_exp_f32 v115, v115
    v_mfma_f32_16x16x32_bf16 v[40:43], a[52:55], a[204:207], v[40:43]
    v_cvt_pk_bf16_f32 v208, v16, v17
    v_cvt_pk_bf16_f32 v209, v18, v19
    v_mfma_f32_16x16x32_bf16 v[44:47], a[76:79], a[204:207], v[44:47]
    s_waitcnt lgkmcnt(4)
    v_cvt_pk_bf16_f32 v210, v20, v21
    v_cvt_pk_bf16_f32 v211, v22, v23
    v_mfma_f32_16x16x32_bf16 v[32:35], a[8:11], a[208:211], v[32:35]
    ds_read_b128 a[204:207], v4 offset:52224
    ds_read_b128 a[200:203], v4 offset:51200
    v_mfma_f32_16x16x32_bf16 v[36:39], a[32:35], a[208:211], v[36:39]
    v_cvt_pk_bf16_f32 v212, v24, v25
    v_cvt_pk_bf16_f32 v213, v26, v27
    v_mfma_f32_16x16x32_bf16 v[40:43], a[56:59], a[208:211], v[40:43]
    v_cvt_pk_bf16_f32 v214, v28, v29
    v_cvt_pk_bf16_f32 v215, v30, v31
    v_mfma_f32_16x16x32_bf16 v[44:47], a[80:83], a[208:211], v[44:47]
    buffer_store_dword v58, v1, s[20:23], s34 offen offset:0 sc1
    v_mfma_f32_16x16x32_bf16 v[64:67], v[128:131], v[208:211], 0
    v_cvt_pk_bf16_f32 v59, v225, v229
    v_cvt_pk_bf16_f32 v60, v226, v230
    v_mfma_f32_16x16x32_bf16 v[72:75], v[136:139], v[208:211], 0
    buffer_store_dword v59, v1, s[20:23], s34 offen offset:384 sc1
    v_mfma_f32_16x16x32_bf16 v[80:83], v[144:147], v[208:211], 0
    v_cvt_pk_bf16_f32 v61, v227, v231
    v_add_f32 v7, v7, v111
    v_mfma_f32_16x16x32_bf16 v[88:91], v[152:155], v[208:211], 0
    v_fma_f32 v116, v116, s29, -v6
    v_fma_f32 v117, v117, s29, -v6
    v_mfma_f32_16x16x32_bf16 v[64:67], v[132:135], v[212:215], v[64:67]
    buffer_store_dword v60, v1, s[20:23], s34 offen offset:768 sc1
    v_mfma_f32_16x16x32_bf16 v[72:75], v[140:143], v[212:215], v[72:75]
    v_exp_f32 v116, v116
    v_mfma_f32_16x16x32_bf16 v[80:83], v[148:151], v[212:215], v[80:83]
    v_cvt_pk_bf16_f32 v58, v232, v236
    v_add_f32 v8, v112, v113
    v_mfma_f32_16x16x32_bf16 v[88:91], v[156:159], v[212:215], v[88:91]
    v_exp_f32 v117, v117
    v_mfma_f32_16x16x32_bf16 v[32:35], a[12:15], a[212:215], v[32:35]
    buffer_store_dword v61, v1, s[20:23], s34 offen offset:1152 sc1
    v_mfma_f32_16x16x32_bf16 v[36:39], a[36:39], a[212:215], v[36:39]
    v_fma_f32 v118, v118, s29, -v6
    v_fma_f32 v119, v119, s29, -v6
    v_mfma_f32_16x16x32_bf16 v[40:43], a[60:63], a[212:215], v[40:43]
    v_cvt_pk_bf16_f32 v59, v233, v237
    v_add_f32 v8, v8, v114
    v_mfma_f32_16x16x32_bf16 v[44:47], a[84:87], a[212:215], v[44:47]
    s_waitcnt lgkmcnt(4)
    v_exp_f32 v118, v118
    v_mfma_f32_16x16x32_bf16 v[32:35], a[16:19], a[216:219], v[32:35]
    ds_read_b128 a[212:215], v4 offset:54272
    ds_read_b128 a[208:211], v4 offset:53248
    v_mfma_f32_16x16x32_bf16 v[36:39], a[40:43], a[216:219], v[36:39]
    buffer_store_dword v58, v1, s[20:23], s30 offen offset:0 sc1
    v_mfma_f32_16x16x32_bf16 v[40:43], a[64:67], a[216:219], v[40:43]
    v_cvt_pk_bf16_f32 v60, v234, v238
    v_add_f32 v8, v8, v115
    v_mfma_f32_16x16x32_bf16 v[44:47], a[88:91], a[216:219], v[44:47]
    v_exp_f32 v119, v119
    v_mfma_f32_16x16x32_bf16 v[32:35], a[20:23], a[220:223], v[32:35]
    buffer_store_dword v59, v1, s[20:23], s30 offen offset:384 sc1
    v_mfma_f32_16x16x32_bf16 v[36:39], a[44:47], a[220:223], v[36:39]
    v_fma_f32 v120, v120, s29, -v6
    v_fma_f32 v121, v121, s29, -v6
    v_mfma_f32_16x16x32_bf16 v[40:43], a[68:71], a[220:223], v[40:43]
    v_cvt_pk_bf16_f32 v61, v235, v239
    v_add_f32 v8, v8, v116
    v_mfma_f32_16x16x32_bf16 v[44:47], a[92:95], a[220:223], v[44:47]
hop3:
    s_cbranch_execz hop4
    s_waitcnt lgkmcnt(4)
    v_exp_f32 v120, v120
    v_mfma_f32_16x16x32_bf16 v[16:19], a[0:3], a[192:195], 0
    ds_read_b128 a[220:223], v4 offset:56320
    ds_read_b128 a[216:219], v4 offset:55296
    v_mfma_f32_16x16x32_bf16 v[20:23], a[24:27], a[192:195], 0
    buffer_store_dword v60, v1, s[20:23], s30 offen offset:768 sc1
    v_mfma_f32_16x16x32_bf16 v[24:27], a[48:51], a[192:195], 0
    v_cvt_pk_bf16_f32 v58, v240, v244
    v_add_f32 v8, v8, v117
    v_mfma_f32_16x16x32_bf16 v[28:31], a[72:75], a[192:195], 0
    v_exp_f32 v121, v121
    v_mfma_f32_16x16x32_bf16 v[16:19], a[4:7], a[196:199], v[16:19]
    buffer_store_dword v61, v1, s[20:23], s30 offen offset:1152 sc1
    v_mfma_f32_16x16x32_bf16 v[20:23], a[28:31], a[196:199], v[20:23]
    v_fma_f32 v122, v122, s29, -v6
    v_fma_f32 v123, v123, s29, -v6
    v_mfma_f32_16x16x32_bf16 v[24:27], a[52:55], a[196:199], v[24:27]
    v_cvt_pk_bf16_f32 v192, v32, v33
    v_cvt_pk_bf16_f32 v193, v34, v35
    v_mfma_f32_16x16x32_bf16 v[28:31], a[76:79], a[196:199], v[28:31]
    s_waitcnt lgkmcnt(4)
    v_cvt_pk_bf16_f32 v194, v36, v37
    v_cvt_pk_bf16_f32 v195, v38, v39
    v_mfma_f32_16x16x32_bf16 v[16:19], a[8:11], a[200:203], v[16:19]
    ds_read_b128 a[196:199], v4 offset:58368
    ds_read_b128 a[192:195], v4 offset:57344
    v_mfma_f32_16x16x32_bf16 v[20:23], a[32:35], a[200:203], v[20:23]
    v_cvt_pk_bf16_f32 v196, v40, v41
    v_cvt_pk_bf16_f32 v197, v42, v43
    v_mfma_f32_16x16x32_bf16 v[24:27], a[56:59], a[200:203], v[24:27]
    v_cvt_pk_bf16_f32 v198, v44, v45
    v_cvt_pk_bf16_f32 v199, v46, v47
    v_mfma_f32_16x16x32_bf16 v[28:31], a[80:83], a[200:203], v[28:31]
    buffer_store_dword v58, v1, s[20:23], s31 offen offset:0 sc1
    v_mfma_f32_16x16x32_bf16 v[68:71], v[128:131], v[192:195], 0
    v_cvt_pk_bf16_f32 v59, v241, v245
    v_cvt_pk_bf16_f32 v60, v242, v246
    v_mfma_f32_16x16x32_bf16 v[76:79], v[136:139], v[192:195], 0
    buffer_store_dword v59, v1, s[20:23], s31 offen offset:384 sc1
    v_mfma_f32_16x16x32_bf16 v[84:87], v[144:147], v[192:195], 0
    v_cvt_pk_bf16_f32 v61, v243, v247
    v_add_f32 v8, v8, v118
    v_mfma_f32_16x16x32_bf16 v[92:95], v[152:155], v[192:195], 0
    v_exp_f32 v122, v122
    v_mfma_f32_16x16x32_bf16 v[68:71], v[132:135], v[196:199], v[68:71]
    buffer_store_dword v60, v1, s[20:23], s31 offen offset:768 sc1
    v_mfma_f32_16x16x32_bf16 v[76:79], v[140:143], v[196:199], v[76:79]
    v_exp_f32 v123, v123
    v_mfma_f32_16x16x32_bf16 v[84:87], v[148:151], v[196:199], v[84:87]
    v_add_f32 v8, v8, v119
    v_fma_f32 v124, v124, s29, -v6
    v_mfma_f32_16x16x32_bf16 v[92:95], v[156:159], v[196:199], v[92:95]
    v_exp_f32 v124, v124
    v_mfma_f32_16x16x32_bf16 v[16:19], a[12:15], a[204:207], v[16:19]
    buffer_store_dword v61, v1, s[20:23], s31 offen offset:1152 sc1
    v_mfma_f32_16x16x32_bf16 v[20:23], a[36:39], a[204:207], v[20:23]
    v_fma_f32 v125, v125, s29, -v6
    v_add_f32 v8, v8, v120
    v_mfma_f32_16x16x32_bf16 v[24:27], a[60:63], a[204:207], v[24:27]
    v_exp_f32 v125, v125
    v_mfma_f32_16x16x32_bf16 v[28:31], a[84:87], a[204:207], v[28:31]
    s_waitcnt lgkmcnt(4)
    v_add_f32 v8, v8, v121
    v_fma_f32 v126, v126, s29, -v6
    v_mfma_f32_16x16x32_bf16 v[16:19], a[16:19], a[208:211], v[16:19]
    ds_read_b128 a[204:207], v4 offset:60416
    ds_read_b128 a[200:203], v4 offset:59392
    v_mfma_f32_16x16x32_bf16 v[20:23], a[40:43], a[208:211], v[20:23]
    v_cvt_pk_bf16_f32 v58, v64, v68
    v_cvt_pk_bf16_f32 v59, v65, v69
    v_mfma_f32_16x16x32_bf16 v[24:27], a[64:67], a[208:211], v[24:27]
    buffer_store_dword v58, v1, s[20:23], s32 offen offset:128 sc1
    v_mfma_f32_16x16x32_bf16 v[28:31], a[88:91], a[208:211], v[28:31]
    v_cvt_pk_bf16_f32 v60, v66, v70
    v_fma_f32 v127, v127, s29, -v6
    v_mfma_f32_16x16x32_bf16 v[16:19], a[20:23], a[212:215], v[16:19]
    buffer_store_dword v59, v1, s[20:23], s32 offen offset:512 sc1
    v_mfma_f32_16x16x32_bf16 v[20:23], a[44:47], a[212:215], v[20:23]
    v_exp_f32 v126, v126
    v_mfma_f32_16x16x32_bf16 v[24:27], a[68:71], a[212:215], v[24:27]
    v_cvt_pk_bf16_f32 v61, v67, v71
    v_add_f32 v8, v8, v122
    v_mfma_f32_16x16x32_bf16 v[28:31], a[92:95], a[212:215], v[28:31]
    s_waitcnt lgkmcnt(4)
    v_exp_f32 v127, v127
    v_mfma_f32_16x16x32_bf16 v[32:35], a[0:3], a[216:219], 0
    ds_read_b128 a[212:215], v4 offset:1024
    ds_read_b128 a[208:211], v4 offset:0
    v_mfma_f32_16x16x32_bf16 v[36:39], a[24:27], a[216:219], 0
    buffer_store_dword v60, v1, s[20:23], s32 offen offset:896 sc1
    v_mfma_f32_16x16x32_bf16 v[40:43], a[48:51], a[216:219], 0
    v_cvt_pk_bf16_f32 v58, v72, v76
    v_add_f32 v8, v8, v123
    v_mfma_f32_16x16x32_bf16 v[44:47], a[72:75], a[216:219], 0
    v_add_f32 v8, v8, v124
    v_add_f32 v8, v8, v125
    v_mfma_f32_16x16x32_bf16 v[32:35], a[4:7], a[220:223], v[32:35]
    buffer_store_dword v61, v1, s[20:23], s32 offen offset:1280 sc1
    v_mfma_f32_16x16x32_bf16 v[36:39], a[28:31], a[220:223], v[36:39]
    v_add_f32 v8, v8, v126
    v_add_f32 v8, v8, v127
    v_mfma_f32_16x16x32_bf16 v[40:43], a[52:55], a[220:223], v[40:43]
    v_cvt_pk_bf16_f32 v200, v16, v17
    v_cvt_pk_bf16_f32 v201, v18, v19
    v_mfma_f32_16x16x32_bf16 v[44:47], a[76:79], a[220:223], v[44:47]
    s_waitcnt lgkmcnt(4)
    v_cvt_pk_bf16_f32 v202, v20, v21
    v_cvt_pk_bf16_f32 v203, v22, v23
    v_mfma_f32_16x16x32_bf16 v[32:35], a[8:11], a[192:195], v[32:35]
    ds_read_b128 a[220:223], v4 offset:3072
    ds_read_b128 a[216:219], v4 offset:2048
    v_mfma_f32_16x16x32_bf16 v[36:39], a[32:35], a[192:195], v[36:39]
    v_cvt_pk_bf16_f32 v204, v24, v25
    v_cvt_pk_bf16_f32 v205, v26, v27
    v_mfma_f32_16x16x32_bf16 v[40:43], a[56:59], a[192:195], v[40:43]
    v_cvt_pk_bf16_f32 v206, v28, v29
    v_cvt_pk_bf16_f32 v207, v30, v31
    v_mfma_f32_16x16x32_bf16 v[44:47], a[80:83], a[192:195], v[44:47]
    buffer_store_dword v58, v1, s[20:23], s34 offen offset:128 sc1
    v_mfma_f32_16x16x32_bf16 v[216:219], v[128:131], v[200:203], 0
    v_cvt_pk_bf16_f32 v59, v73, v77
    v_cvt_pk_bf16_f32 v60, v74, v78
    v_mfma_f32_16x16x32_bf16 v[224:227], v[136:139], v[200:203], 0
    buffer_store_dword v59, v1, s[20:23], s34 offen offset:512 sc1
    v_mfma_f32_16x16x32_bf16 v[232:235], v[144:147], v[200:203], 0
    v_cvt_pk_bf16_f32 v61, v75, v79
    v_permlane32_swap_b32 v7, v8
    v_mfma_f32_16x16x32_bf16 v[240:243], v[152:155], v[200:203], 0
    v_add_f32 v7, v7, v8
    v_mov_b32 v8, v7
    v_mfma_f32_16x16x32_bf16 v[216:219], v[132:135], v[204:207], v[216:219]
    buffer_store_dword v60, v1, s[20:23], s34 offen offset:896 sc1
    v_mfma_f32_16x16x32_bf16 v[224:227], v[140:143], v[204:207], v[224:227]
    v_permlane16_swap_b32 v7, v8
    v_add_f32 v7, v7, v8
    v_mfma_f32_16x16x32_bf16 v[232:235], v[148:151], v[204:207], v[232:235]
    v_cvt_pk_bf16_f32 v58, v80, v84
    v_mfma_f32_16x16x32_bf16 v[240:243], v[156:159], v[204:207], v[240:243]
    v_rcp_f32 v7, v7
    v_mfma_f32_16x16x32_bf16 v[32:35], a[12:15], a[196:199], v[32:35]
    buffer_store_dword v61, v1, s[20:23], s34 offen offset:1280 sc1
    v_mfma_f32_16x16x32_bf16 v[36:39], a[36:39], a[196:199], v[36:39]
    v_mov_b32 v8, v7
    v_mfma_f32_16x16x32_bf16 v[40:43], a[60:63], a[196:199], v[40:43]
    v_cvt_pk_bf16_f32 v59, v81, v85
    v_mfma_f32_16x16x32_bf16 v[44:47], a[84:87], a[196:199], v[44:47]
    s_waitcnt lgkmcnt(4)
    v_permlane32_swap_b32 v7, v8
    v_mul_f32 v96, v7, v96
    v_mfma_f32_16x16x32_bf16 v[32:35], a[16:19], a[200:203], v[32:35]
    ds_read_b128 a[196:199], v4 offset:5120
    ds_read_b128 a[192:195], v4 offset:4096
    v_mfma_f32_16x16x32_bf16 v[36:39], a[40:43], a[200:203], v[36:39]
    buffer_store_dword v58, v1, s[20:23], s30 offen offset:128 sc1
    v_mfma_f32_16x16x32_bf16 v[40:43], a[64:67], a[200:203], v[40:43]
    v_cvt_pk_bf16_f32 v60, v82, v86
    v_mul_f32 v97, v7, v97
    v_mfma_f32_16x16x32_bf16 v[44:47], a[88:91], a[200:203], v[44:47]
    v_cvt_pk_bf16_f32 v160, v96, v97
    v_mul_f32 v98, v7, v98
    v_mfma_f32_16x16x32_bf16 v[32:35], a[20:23], a[204:207], v[32:35]
    buffer_store_dword v59, v1, s[20:23], s30 offen offset:512 sc1
    v_mfma_f32_16x16x32_bf16 v[36:39], a[44:47], a[204:207], v[36:39]
    v_mul_f32 v99, v7, v99
    v_cvt_pk_bf16_f32 v161, v98, v99
    v_mfma_f32_16x16x32_bf16 v[40:43], a[68:71], a[204:207], v[40:43]
    v_cvt_pk_bf16_f32 v61, v83, v87
    v_mul_f32 v100, v7, v100
    v_mfma_f32_16x16x32_bf16 v[44:47], a[92:95], a[204:207], v[44:47]
    s_waitcnt lgkmcnt(4)
    v_mul_f32 v101, v7, v101
    v_cvt_pk_bf16_f32 v162, v100, v101
    v_mfma_f32_16x16x32_bf16 v[16:19], a[96:99], a[208:211], 0
    ds_read_b128 a[204:207], v4 offset:7168
    ds_read_b128 a[200:203], v4 offset:6144
    v_mfma_f32_16x16x32_bf16 v[20:23], a[120:123], a[208:211], 0
    buffer_store_dword v60, v1, s[20:23], s30 offen offset:896 sc1
    v_mfma_f32_16x16x32_bf16 v[24:27], a[144:147], a[208:211], 0
    v_cvt_pk_bf16_f32 v58, v88, v92
    v_mul_f32 v102, v7, v102
    v_mfma_f32_16x16x32_bf16 v[28:31], a[168:171], a[208:211], 0
    ds_write_b64 v56, v[160:161] offset:0
    v_mfma_f32_16x16x32_bf16 v[16:19], a[100:103], a[212:215], v[16:19]
    buffer_store_dword v61, v1, s[20:23], s30 offen offset:1280 sc1
    v_mfma_f32_16x16x32_bf16 v[20:23], a[124:127], a[212:215], v[20:23]
    v_mul_f32 v103, v7, v103
    v_cvt_pk_bf16_f32 v163, v102, v103
    v_mfma_f32_16x16x32_bf16 v[24:27], a[148:151], a[212:215], v[24:27]
    v_cvt_pk_bf16_f32 v208, v32, v33
    v_cvt_pk_bf16_f32 v209, v34, v35
    v_mfma_f32_16x16x32_bf16 v[28:31], a[172:175], a[212:215], v[28:31]
    s_waitcnt lgkmcnt(5)
    v_cvt_pk_bf16_f32 v210, v36, v37
    v_cvt_pk_bf16_f32 v211, v38, v39
    v_mfma_f32_16x16x32_bf16 v[16:19], a[104:107], a[216:219], v[16:19]
    ds_read_b128 a[212:215], v4 offset:9216
    ds_read_b128 a[208:211], v4 offset:8192
    v_mfma_f32_16x16x32_bf16 v[20:23], a[128:131], a[216:219], v[20:23]
    v_cvt_pk_bf16_f32 v212, v40, v41
    v_cvt_pk_bf16_f32 v213, v42, v43
    v_mfma_f32_16x16x32_bf16 v[24:27], a[152:155], a[216:219], v[24:27]
    v_cvt_pk_bf16_f32 v214, v44, v45
    v_cvt_pk_bf16_f32 v215, v46, v47
    v_mfma_f32_16x16x32_bf16 v[28:31], a[176:179], a[216:219], v[28:31]
    buffer_store_dword v58, v1, s[20:23], s31 offen offset:128 sc1
    v_mfma_f32_16x16x32_bf16 v[220:223], v[128:131], v[208:211], 0
    v_cvt_pk_bf16_f32 v59, v89, v93
    v_cvt_pk_bf16_f32 v60, v90, v94
    v_mfma_f32_16x16x32_bf16 v[228:231], v[136:139], v[208:211], 0
    buffer_store_dword v59, v1, s[20:23], s31 offen offset:512 sc1
    v_mfma_f32_16x16x32_bf16 v[236:239], v[144:147], v[208:211], 0
    v_cvt_pk_bf16_f32 v61, v91, v95
    v_mul_f32 v104, v7, v104
    v_mfma_f32_16x16x32_bf16 v[244:247], v[152:155], v[208:211], 0
    ds_write_b64 v56, v[162:163] offset:8
    v_mfma_f32_16x16x32_bf16 v[220:223], v[132:135], v[212:215], v[220:223]
    buffer_store_dword v60, v1, s[20:23], s31 offen offset:896 sc1
    v_mfma_f32_16x16x32_bf16 v[228:231], v[140:143], v[212:215], v[228:231]
    v_mul_f32 v105, v7, v105
    v_cvt_pk_bf16_f32 v164, v104, v105
    v_mfma_f32_16x16x32_bf16 v[236:239], v[148:151], v[212:215], v[236:239]
    v_mul_f32 v106, v7, v106
    v_mul_f32 v107, v7, v107
    v_mfma_f32_16x16x32_bf16 v[244:247], v[156:159], v[212:215], v[244:247]
    v_cvt_pk_bf16_f32 v165, v106, v107
    v_mul_f32 v108, v7, v108
    v_mfma_f32_16x16x32_bf16 v[16:19], a[108:111], a[220:223], v[16:19]
    buffer_store_dword v61, v1, s[20:23], s31 offen offset:1280 sc1
    v_mfma_f32_16x16x32_bf16 v[20:23], a[132:135], a[220:223], v[20:23]
    ds_write_b64 v56, v[164:165] offset:1024
    v_mfma_f32_16x16x32_bf16 v[24:27], a[156:159], a[220:223], v[24:27]
    v_mul_f32 v109, v7, v109
    v_cvt_pk_bf16_f32 v166, v108, v109
    v_mfma_f32_16x16x32_bf16 v[28:31], a[180:183], a[220:223], v[28:31]
    s_waitcnt lgkmcnt(7)
    v_mul_f32 v110, v7, v110
    v_mul_f32 v111, v7, v111
    v_mfma_f32_16x16x32_bf16 v[16:19], a[112:115], a[192:195], v[16:19]
    ds_read_b128 a[220:223], v4 offset:11264
    ds_read_b128 a[216:219], v4 offset:10240
    v_mfma_f32_16x16x32_bf16 v[20:23], a[136:139], a[192:195], v[20:23]
    v_cvt_pk_bf16_f32 v58, v216, v220
    v_cvt_pk_bf16_f32 v59, v217, v221
    v_mfma_f32_16x16x32_bf16 v[24:27], a[160:163], a[192:195], v[24:27]
    buffer_store_dword v58, v1, s[20:23], s32 offen offset:256 sc1
    v_mfma_f32_16x16x32_bf16 v[28:31], a[184:187], a[192:195], v[28:31]
    v_cvt_pk_bf16_f32 v167, v110, v111
    v_mul_f32 v112, v8, v112
    v_mfma_f32_16x16x32_bf16 v[16:19], a[116:119], a[196:199], v[16:19]
    v_cvt_pk_bf16_f32 v60, v218, v222
    v_mul_f32 v113, v8, v113
    v_mfma_f32_16x16x32_bf16 v[20:23], a[140:143], a[196:199], v[20:23]
    buffer_store_dword v59, v1, s[20:23], s32 offen offset:640 sc1
    v_mfma_f32_16x16x32_bf16 v[24:27], a[164:167], a[196:199], v[24:27]
    ds_write_b64 v56, v[166:167] offset:1032
    v_mfma_f32_16x16x32_bf16 v[28:31], a[188:191], a[196:199], v[28:31]
    s_waitcnt lgkmcnt(8)
    v_cvt_pk_bf16_f32 v168, v112, v113
    v_mul_f32 v114, v8, v114
    v_mfma_f32_16x16x32_bf16 v[32:35], a[96:99], a[200:203], 0
    ds_read_b128 a[196:199], v4 offset:25600
    ds_read_b128 a[192:195], v4 offset:24576
    v_mfma_f32_16x16x32_bf16 v[36:39], a[120:123], a[200:203], 0
    v_cvt_pk_bf16_f32 v61, v219, v223
    v_mul_f32 v115, v8, v115
    v_mfma_f32_16x16x32_bf16 v[40:43], a[144:147], a[200:203], 0
    buffer_store_dword v60, v1, s[20:23], s32 offen offset:1024 sc1
    v_mfma_f32_16x16x32_bf16 v[44:47], a[168:171], a[200:203], 0
    v_cvt_pk_bf16_f32 v169, v114, v115
    v_mul_f32 v116, v8, v116
    v_mfma_f32_16x16x32_bf16 v[32:35], a[100:103], a[204:207], v[32:35]
    ds_write_b64 v56, v[168:169] offset:2048
    v_mfma_f32_16x16x32_bf16 v[36:39], a[124:127], a[204:207], v[36:39]
    v_mul_f32 v117, v8, v117
    v_cvt_pk_bf16_f32 v170, v116, v117
    v_mfma_f32_16x16x32_bf16 v[40:43], a[148:151], a[204:207], v[40:43]
    v_cvt_pk_bf16_f32 v192, v16, v17
    v_cvt_pk_bf16_f32 v193, v18, v19
    v_mfma_f32_16x16x32_bf16 v[44:47], a[172:175], a[204:207], v[44:47]
    s_waitcnt lgkmcnt(8)
    v_cvt_pk_bf16_f32 v194, v20, v21
    v_cvt_pk_bf16_f32 v195, v22, v23
    v_mfma_f32_16x16x32_bf16 v[32:35], a[104:107], a[208:211], v[32:35]
hop4:
    s_cbranch_execz hop5
    ds_read_b128 a[204:207], v4 offset:27648
    ds_read_b128 a[200:203], v4 offset:26624
    v_mfma_f32_16x16x32_bf16 v[36:39], a[128:131], a[208:211], v[36:39]
    v_cvt_pk_bf16_f32 v196, v24, v25
    v_cvt_pk_bf16_f32 v197, v26, v27
    v_mfma_f32_16x16x32_bf16 v[40:43], a[152:155], a[208:211], v[40:43]
    v_cvt_pk_bf16_f32 v198, v28, v29
    v_cvt_pk_bf16_f32 v199, v30, v31
    v_mfma_f32_16x16x32_bf16 v[44:47], a[176:179], a[208:211], v[44:47]
    buffer_store_dword v61, v1, s[20:23], s32 offen offset:1408 sc1
    v_mfma_f32_16x16x32_bf16 v[32:35], a[108:111], a[212:215], v[32:35]
    v_cvt_pk_bf16_f32 v58, v224, v228
    v_cvt_pk_bf16_f32 v59, v225, v229
    v_mfma_f32_16x16x32_bf16 v[36:39], a[132:135], a[212:215], v[36:39]
    buffer_store_dword v58, v1, s[20:23], s34 offen offset:256 sc1
    v_mfma_f32_16x16x32_bf16 v[40:43], a[156:159], a[212:215], v[40:43]
    v_mul_f32 v118, v8, v118
    v_mul_f32 v119, v8, v119
    v_mfma_f32_16x16x32_bf16 v[44:47], a[180:183], a[212:215], v[44:47]
    s_waitcnt lgkmcnt(6)
    v_cvt_pk_bf16_f32 v171, v118, v119
    v_mul_f32 v120, v8, v120
    v_mfma_f32_16x16x32_bf16 v[32:35], a[112:115], a[216:219], v[32:35]
    ds_read_b128 a[212:215], v4 offset:29696
    ds_read_b128 a[208:211], v4 offset:28672
    v_mfma_f32_16x16x32_bf16 v[36:39], a[136:139], a[216:219], v[36:39]
    buffer_store_dword v59, v1, s[20:23], s34 offen offset:640 sc1
    v_mfma_f32_16x16x32_bf16 v[40:43], a[160:163], a[216:219], v[40:43]
    v_cvt_pk_bf16_f32 v60, v226, v230
    v_mul_f32 v121, v8, v121
    v_mfma_f32_16x16x32_bf16 v[44:47], a[184:187], a[216:219], v[44:47]
    ds_write_b64 v56, v[170:171] offset:2056
    v_mfma_f32_16x16x32_bf16 v[32:35], a[116:119], a[220:223], v[32:35]
    v_cvt_pk_bf16_f32 v172, v120, v121
    v_mul_f32 v122, v8, v122
    v_mfma_f32_16x16x32_bf16 v[36:39], a[140:143], a[220:223], v[36:39]
    v_cvt_pk_bf16_f32 v61, v227, v231
    v_mul_f32 v123, v8, v123
    v_mfma_f32_16x16x32_bf16 v[40:43], a[164:167], a[220:223], v[40:43]
    buffer_store_dword v60, v1, s[20:23], s34 offen offset:1024 sc1
    v_mfma_f32_16x16x32_bf16 v[44:47], a[188:191], a[220:223], v[44:47]
    s_waitcnt lgkmcnt(6)
    v_cvt_pk_bf16_f32 v173, v122, v123
    v_mul_f32 v124, v8, v124
    v_mfma_f32_16x16x32_bf16 v[16:19], a[96:99], a[192:195], 0
    ds_read_b128 a[220:223], v4 offset:31744
    ds_read_b128 a[216:219], v4 offset:30720
    v_mfma_f32_16x16x32_bf16 v[20:23], a[120:123], a[192:195], 0
    ds_write_b64 v56, v[172:173] offset:3072
    v_mfma_f32_16x16x32_bf16 v[24:27], a[144:147], a[192:195], 0
    v_cvt_pk_bf16_f32 v58, v232, v236
    v_mul_f32 v125, v8, v125
    v_mfma_f32_16x16x32_bf16 v[28:31], a[168:171], a[192:195], 0
    buffer_store_dword v61, v1, s[20:23], s34 offen offset:1408 sc1
    v_mfma_f32_16x16x32_bf16 v[16:19], a[100:103], a[196:199], v[16:19]
    v_cvt_pk_bf16_f32 v174, v124, v125
    v_mul_f32 v126, v8, v126
    v_mfma_f32_16x16x32_bf16 v[20:23], a[124:127], a[196:199], v[20:23]
    v_mul_f32 v127, v8, v127
    v_cvt_pk_bf16_f32 v175, v126, v127
    v_mfma_f32_16x16x32_bf16 v[24:27], a[148:151], a[196:199], v[24:27]
    v_cvt_pk_bf16_f32 v200, v32, v33
    v_cvt_pk_bf16_f32 v201, v34, v35
    v_mfma_f32_16x16x32_bf16 v[28:31], a[172:175], a[196:199], v[28:31]
    s_waitcnt lgkmcnt(6)
    v_cvt_pk_bf16_f32 v202, v36, v37
    v_cvt_pk_bf16_f32 v203, v38, v39
    v_mfma_f32_16x16x32_bf16 v[16:19], a[104:107], a[200:203], v[16:19]
    ds_read_b128 a[196:199], v4 offset:33792
    ds_read_b128 a[192:195], v4 offset:32768
    v_mfma_f32_16x16x32_bf16 v[20:23], a[128:131], a[200:203], v[20:23]
    v_cvt_pk_bf16_f32 v204, v40, v41
    v_cvt_pk_bf16_f32 v205, v42, v43
    v_mfma_f32_16x16x32_bf16 v[24:27], a[152:155], a[200:203], v[24:27]
    v_cvt_pk_bf16_f32 v206, v44, v45
    v_cvt_pk_bf16_f32 v207, v46, v47
    v_mfma_f32_16x16x32_bf16 v[28:31], a[176:179], a[200:203], v[28:31]
    buffer_store_dword v58, v1, s[20:23], s30 offen offset:256 sc1
    v_mfma_f32_16x16x32_bf16 v[16:19], a[108:111], a[204:207], v[16:19]
    v_cvt_pk_bf16_f32 v59, v233, v237
    v_cvt_pk_bf16_f32 v60, v234, v238
    v_mfma_f32_16x16x32_bf16 v[20:23], a[132:135], a[204:207], v[20:23]
    buffer_store_dword v59, v1, s[20:23], s30 offen offset:640 sc1
    v_mfma_f32_16x16x32_bf16 v[24:27], a[156:159], a[204:207], v[24:27]
    ds_write_b64 v56, v[174:175] offset:3080
    v_mfma_f32_16x16x32_bf16 v[28:31], a[180:183], a[204:207], v[28:31]
    s_waitcnt lgkmcnt(7)
    v_mfma_f32_16x16x32_bf16 v[16:19], a[112:115], a[208:211], v[16:19]
    ds_read_b128 a[204:207], v4 offset:35840
    ds_read_b128 a[200:203], v4 offset:34816
    v_mfma_f32_16x16x32_bf16 v[20:23], a[136:139], a[208:211], v[20:23]
    v_cvt_pk_bf16_f32 v61, v235, v239
    v_mfma_f32_16x16x32_bf16 v[24:27], a[160:163], a[208:211], v[24:27]
    buffer_store_dword v60, v1, s[20:23], s30 offen offset:1024 sc1
    v_mfma_f32_16x16x32_bf16 v[28:31], a[184:187], a[208:211], v[28:31]
    s_waitcnt lgkmcnt(2)
    s_barrier
    v_mfma_f32_16x16x32_bf16 v[16:19], a[116:119], a[212:215], v[16:19]
    ds_read_b128 v[180:183], v57 offset:0
    ds_read_b128 v[176:179], v57 offset:1024
    v_mfma_f32_16x16x32_bf16 v[20:23], a[140:143], a[212:215], v[20:23]
    ds_read_b128 v[188:191], v57 offset:2048
    ds_read_b128 v[184:187], v57 offset:3072
    v_mfma_f32_16x16x32_bf16 v[24:27], a[164:167], a[212:215], v[24:27]
    v_cvt_pk_bf16_f32 v58, v240, v244
    v_mfma_f32_16x16x32_bf16 v[28:31], a[188:191], a[212:215], v[28:31]
    v_mfma_f32_16x16x32_bf16 v[64:67], v[160:163], v[192:195], 0
    buffer_store_dword v61, v1, s[20:23], s30 offen offset:1408 sc1
    v_mfma_f32_16x16x32_bf16 v[72:75], v[168:171], v[192:195], 0
    s_waitcnt lgkmcnt(2)
    v_mfma_f32_16x16x32_bf16 v[80:83], v[176:179], v[192:195], 0
    s_waitcnt lgkmcnt(0)
    v_mfma_f32_16x16x32_bf16 v[88:91], v[184:187], v[192:195], 0
    v_cvt_pk_bf16_f32 v59, v241, v245
    v_mfma_f32_16x16x32_bf16 v[64:67], v[164:167], v[196:199], v[64:67]
    buffer_store_dword v58, v1, s[20:23], s31 offen offset:256 sc1
    v_mfma_f32_16x16x32_bf16 v[72:75], v[172:175], v[196:199], v[72:75]
    v_mfma_f32_16x16x32_bf16 v[80:83], v[180:183], v[196:199], v[80:83]
    v_mfma_f32_16x16x32_bf16 v[88:91], v[188:191], v[196:199], v[88:91]
    v_mfma_f32_16x16x32_bf16 v[68:71], v[160:163], v[200:203], 0
    v_cvt_pk_bf16_f32 v60, v242, v246
    v_mfma_f32_16x16x32_bf16 v[76:79], v[168:171], v[200:203], 0
    buffer_store_dword v59, v1, s[20:23], s31 offen offset:640 sc1
    v_mfma_f32_16x16x32_bf16 v[84:87], v[176:179], v[200:203], 0
    v_mfma_f32_16x16x32_bf16 v[92:95], v[184:187], v[200:203], 0
    v_mfma_f32_16x16x32_bf16 v[68:71], v[164:167], v[204:207], v[68:71]
    v_mfma_f32_16x16x32_bf16 v[76:79], v[172:175], v[204:207], v[76:79]
    v_cvt_pk_bf16_f32 v61, v243, v247
    v_mfma_f32_16x16x32_bf16 v[84:87], v[180:183], v[204:207], v[84:87]
    buffer_store_dword v60, v1, s[20:23], s31 offen offset:1024 sc1
    v_mfma_f32_16x16x32_bf16 v[92:95], v[188:191], v[204:207], v[92:95]
    v_mfma_f32_16x16x32_bf16 v[32:35], a[96:99], a[216:219], 0
    ds_read_b128 a[212:215], v4 offset:50176
    ds_read_b128 a[208:211], v4 offset:49152
    v_mfma_f32_16x16x32_bf16 v[36:39], a[120:123], a[216:219], 0
    v_mfma_f32_16x16x32_bf16 v[40:43], a[144:147], a[216:219], 0
    v_cvt_pk_bf16_f32 v208, v16, v17
    v_cvt_pk_bf16_f32 v209, v18, v19
    v_mfma_f32_16x16x32_bf16 v[44:47], a[168:171], a[216:219], 0
    v_cvt_pk_bf16_f32 v210, v20, v21
    v_cvt_pk_bf16_f32 v211, v22, v23
    v_mfma_f32_16x16x32_bf16 v[32:35], a[100:103], a[220:223], v[32:35]
    v_cvt_pk_bf16_f32 v212, v24, v25
    v_cvt_pk_bf16_f32 v213, v26, v27
    v_mfma_f32_16x16x32_bf16 v[36:39], a[124:127], a[220:223], v[36:39]
    v_cvt_pk_bf16_f32 v214, v28, v29
    v_cvt_pk_bf16_f32 v215, v30, v31
    v_mfma_f32_16x16x32_bf16 v[40:43], a[148:151], a[220:223], v[40:43]
    buffer_store_dword v61, v1, s[20:23], s31 offen offset:1408 sc1
    v_mfma_f32_16x16x32_bf16 v[44:47], a[172:175], a[220:223], v[44:47]
    v_mfma_f32_16x16x32_bf16 v[32:35], a[104:107], a[192:195], v[32:35]
    ds_read_b128 a[220:223], v4 offset:52224
    ds_read_b128 a[216:219], v4 offset:51200
    v_mfma_f32_16x16x32_bf16 v[36:39], a[128:131], a[192:195], v[36:39]
    v_cvt_pk_bf16_f32 v58, v64, v68
    v_cvt_pk_bf16_f32 v59, v65, v69
    v_mfma_f32_16x16x32_bf16 v[40:43], a[152:155], a[192:195], v[40:43]
    buffer_store_dword v58, v13, s[20:23], s32 offen offset:0 sc1
    v_mfma_f32_16x16x32_bf16 v[44:47], a[176:179], a[192:195], v[44:47]
    buffer_store_dword v59, v13, s[20:23], s32 offen offset:384 sc1
    v_mfma_f32_16x16x32_bf16 v[216:219], v[160:163], v[208:211], 0
    v_cvt_pk_bf16_f32 v60, v66, v70
    v_cvt_pk_bf16_f32 v61, v67, v71
    v_mfma_f32_16x16x32_bf16 v[224:227], v[168:171], v[208:211], 0
    v_mfma_f32_16x16x32_bf16 v[232:235], v[176:179], v[208:211], 0
    buffer_store_dword v60, v13, s[20:23], s32 offen offset:768 sc1
    v_mfma_f32_16x16x32_bf16 v[240:243], v[184:187], v[208:211], 0
    v_cvt_pk_bf16_f32 v58, v72, v76
    v_mfma_f32_16x16x32_bf16 v[216:219], v[164:167], v[212:215], v[216:219]
    v_mfma_f32_16x16x32_bf16 v[224:227], v[172:175], v[212:215], v[224:227]
    buffer_store_dword v61, v13, s[20:23], s32 offen offset:1152 sc1
    v_mfma_f32_16x16x32_bf16 v[232:235], v[180:183], v[212:215], v[232:235]
    v_cvt_pk_bf16_f32 v59, v73, v77
    v_mfma_f32_16x16x32_bf16 v[240:243], v[188:191], v[212:215], v[240:243]
    v_mfma_f32_16x16x32_bf16 v[32:35], a[108:111], a[196:199], v[32:35]
    buffer_store_dword v58, v13, s[20:23], s34 offen offset:0 sc1
    v_mfma_f32_16x16x32_bf16 v[36:39], a[132:135], a[196:199], v[36:39]
    v_cvt_pk_bf16_f32 v60, v74, v78
    v_mfma_f32_16x16x32_bf16 v[40:43], a[156:159], a[196:199], v[40:43]
    v_mfma_f32_16x16x32_bf16 v[44:47], a[180:183], a[196:199], v[44:47]
    v_cvt_pk_bf16_f32 v61, v75, v79
    v_mfma_f32_16x16x32_bf16 v[32:35], a[112:115], a[200:203], v[32:35]
    ds_read_b128 a[196:199], v4 offset:54272
    ds_read_b128 a[192:195], v4 offset:53248
    v_mfma_f32_16x16x32_bf16 v[36:39], a[136:139], a[200:203], v[36:39]
    buffer_store_dword v59, v13, s[20:23], s34 offen offset:384 sc1
    v_mfma_f32_16x16x32_bf16 v[40:43], a[160:163], a[200:203], v[40:43]
    buffer_store_dword v60, v13, s[20:23], s34 offen offset:768 sc1
    v_mfma_f32_16x16x32_bf16 v[44:47], a[184:187], a[200:203], v[44:47]
    v_cvt_pk_bf16_f32 v58, v80, v84
    v_mfma_f32_16x16x32_bf16 v[32:35], a[116:119], a[204:207], v[32:35]
    v_mfma_f32_16x16x32_bf16 v[36:39], a[140:143], a[204:207], v[36:39]
    buffer_store_dword v61, v13, s[20:23], s34 offen offset:1152 sc1
    v_mfma_f32_16x16x32_bf16 v[40:43], a[164:167], a[204:207], v[40:43]
    v_cvt_pk_bf16_f32 v59, v81, v85
    v_mfma_f32_16x16x32_bf16 v[44:47], a[188:191], a[204:207], v[44:47]
    s_waitcnt lgkmcnt(4)
    v_mfma_f32_16x16x32_bf16 v[16:19], a[96:99], a[208:211], 0
    ds_read_b128 a[204:207], v4 offset:56320
    ds_read_b128 a[200:203], v4 offset:55296
    v_mfma_f32_16x16x32_bf16 v[20:23], a[120:123], a[208:211], 0
    buffer_store_dword v58, v13, s[20:23], s30 offen offset:0 sc1
    v_mfma_f32_16x16x32_bf16 v[24:27], a[144:147], a[208:211], 0
    v_cvt_pk_bf16_f32 v60, v82, v86
    v_mfma_f32_16x16x32_bf16 v[28:31], a[168:171], a[208:211], 0
    buffer_store_dword v59, v13, s[20:23], s30 offen offset:384 sc1
    v_mfma_f32_16x16x32_bf16 v[16:19], a[100:103], a[212:215], v[16:19]
    v_mfma_f32_16x16x32_bf16 v[20:23], a[124:127], a[212:215], v[20:23]
    v_mfma_f32_16x16x32_bf16 v[24:27], a[148:151], a[212:215], v[24:27]
    v_cvt_pk_bf16_f32 v128, v32, v33
    v_cvt_pk_bf16_f32 v129, v34, v35
    v_mfma_f32_16x16x32_bf16 v[28:31], a[172:175], a[212:215], v[28:31]
    s_waitcnt lgkmcnt(4)
    v_cvt_pk_bf16_f32 v130, v36, v37
    v_cvt_pk_bf16_f32 v131, v38, v39
    v_mfma_f32_16x16x32_bf16 v[16:19], a[104:107], a[216:219], v[16:19]
    ds_read_b128 a[212:215], v4 offset:58368
    ds_read_b128 a[208:211], v4 offset:57344
    v_mfma_f32_16x16x32_bf16 v[20:23], a[128:131], a[216:219], v[20:23]
    v_cvt_pk_bf16_f32 v132, v40, v41
    v_cvt_pk_bf16_f32 v133, v42, v43
    v_mfma_f32_16x16x32_bf16 v[24:27], a[152:155], a[216:219], v[24:27]
    v_cvt_pk_bf16_f32 v134, v44, v45
    v_cvt_pk_bf16_f32 v135, v46, v47
    v_mfma_f32_16x16x32_bf16 v[28:31], a[176:179], a[216:219], v[28:31]
    buffer_store_dword v60, v13, s[20:23], s30 offen offset:768 sc1
    v_mfma_f32_16x16x32_bf16 v[220:223], v[160:163], v[128:131], 0
    v_cvt_pk_bf16_f32 v61, v83, v87
    v_cvt_pk_bf16_f32 v58, v88, v92
    v_mfma_f32_16x16x32_bf16 v[228:231], v[168:171], v[128:131], 0
    buffer_store_dword v61, v13, s[20:23], s30 offen offset:1152 sc1
    v_mfma_f32_16x16x32_bf16 v[236:239], v[176:179], v[128:131], 0
    v_cvt_pk_bf16_f32 v59, v89, v93
    v_mfma_f32_16x16x32_bf16 v[244:247], v[184:187], v[128:131], 0
    buffer_store_dword v58, v13, s[20:23], s31 offen offset:0 sc1
    v_mfma_f32_16x16x32_bf16 v[220:223], v[164:167], v[132:135], v[220:223]
    v_cvt_pk_bf16_f32 v60, v90, v94
    v_mfma_f32_16x16x32_bf16 v[228:231], v[172:175], v[132:135], v[228:231]
    v_mfma_f32_16x16x32_bf16 v[236:239], v[180:183], v[132:135], v[236:239]
    buffer_store_dword v59, v13, s[20:23], s31 offen offset:384 sc1
    v_mfma_f32_16x16x32_bf16 v[244:247], v[188:191], v[132:135], v[244:247]
    v_cvt_pk_bf16_f32 v61, v91, v95
    v_mfma_f32_16x16x32_bf16 v[16:19], a[108:111], a[220:223], v[16:19]
    v_mfma_f32_16x16x32_bf16 v[20:23], a[132:135], a[220:223], v[20:23]
    buffer_store_dword v60, v13, s[20:23], s31 offen offset:768 sc1
    v_mfma_f32_16x16x32_bf16 v[24:27], a[156:159], a[220:223], v[24:27]
    v_mfma_f32_16x16x32_bf16 v[28:31], a[180:183], a[220:223], v[28:31]
    s_waitcnt lgkmcnt(4)
    v_mfma_f32_16x16x32_bf16 v[16:19], a[112:115], a[192:195], v[16:19]
    ds_read_b128 a[220:223], v4 offset:60416
    ds_read_b128 a[216:219], v4 offset:59392
    v_mfma_f32_16x16x32_bf16 v[20:23], a[136:139], a[192:195], v[20:23]
    buffer_store_dword v61, v13, s[20:23], s31 offen offset:1152 sc1
    v_mfma_f32_16x16x32_bf16 v[24:27], a[160:163], a[192:195], v[24:27]
    v_mfma_f32_16x16x32_bf16 v[28:31], a[184:187], a[192:195], v[28:31]
    v_cvt_pk_bf16_f32 v58, v216, v220
    v_cvt_pk_bf16_f32 v59, v217, v221
    v_mfma_f32_16x16x32_bf16 v[16:19], a[116:119], a[196:199], v[16:19]
    buffer_store_dword v58, v13, s[20:23], s32 offen offset:128 sc1
    v_mfma_f32_16x16x32_bf16 v[20:23], a[140:143], a[196:199], v[20:23]
    buffer_store_dword v59, v13, s[20:23], s32 offen offset:512 sc1
    v_mfma_f32_16x16x32_bf16 v[24:27], a[164:167], a[196:199], v[24:27]
    v_cvt_pk_bf16_f32 v60, v218, v222
    v_cvt_pk_bf16_f32 v61, v219, v223
    v_mfma_f32_16x16x32_bf16 v[28:31], a[188:191], a[196:199], v[28:31]
    s_waitcnt lgkmcnt(4)
    v_cvt_pk_bf16_f32 v58, v224, v228
    v_cvt_pk_bf16_f32 v59, v225, v229
    v_mfma_f32_16x16x32_bf16 v[32:35], a[96:99], a[200:203], 0
hop5:
    s_cbranch_execz hop6
    buffer_store_dword v60, v13, s[20:23], s32 offen offset:896 sc1
    v_mfma_f32_16x16x32_bf16 v[36:39], a[120:123], a[200:203], 0
    buffer_store_dword v61, v13, s[20:23], s32 offen offset:1280 sc1
    v_mfma_f32_16x16x32_bf16 v[40:43], a[144:147], a[200:203], 0
    v_cvt_pk_bf16_f32 v60, v226, v230
    v_mfma_f32_16x16x32_bf16 v[44:47], a[168:171], a[200:203], 0
    buffer_store_dword v58, v13, s[20:23], s34 offen offset:128 sc1
    v_mfma_f32_16x16x32_bf16 v[32:35], a[100:103], a[204:207], v[32:35]
    v_mfma_f32_16x16x32_bf16 v[36:39], a[124:127], a[204:207], v[36:39]
    buffer_store_dword v59, v13, s[20:23], s34 offen offset:512 sc1
    v_mfma_f32_16x16x32_bf16 v[40:43], a[148:151], a[204:207], v[40:43]
    v_cvt_pk_bf16_f32 v136, v16, v17
    v_cvt_pk_bf16_f32 v137, v18, v19
    v_mfma_f32_16x16x32_bf16 v[44:47], a[172:175], a[204:207], v[44:47]
    s_waitcnt lgkmcnt(2)
    v_cvt_pk_bf16_f32 v138, v20, v21
    v_cvt_pk_bf16_f32 v139, v22, v23
    v_mfma_f32_16x16x32_bf16 v[32:35], a[104:107], a[208:211], v[32:35]
    v_cvt_pk_bf16_f32 v140, v24, v25
    v_cvt_pk_bf16_f32 v141, v26, v27
    v_mfma_f32_16x16x32_bf16 v[36:39], a[128:131], a[208:211], v[36:39]
    v_cvt_pk_bf16_f32 v142, v28, v29
    v_cvt_pk_bf16_f32 v143, v30, v31
    v_mfma_f32_16x16x32_bf16 v[40:43], a[152:155], a[208:211], v[40:43]
    buffer_store_dword v60, v13, s[20:23], s34 offen offset:896 sc1
    v_mfma_f32_16x16x32_bf16 v[44:47], a[176:179], a[208:211], v[44:47]
    v_cvt_pk_bf16_f32 v61, v227, v231
    v_cvt_pk_bf16_f32 v58, v232, v236
    v_mfma_f32_16x16x32_bf16 v[32:35], a[108:111], a[212:215], v[32:35]
    buffer_store_dword v61, v13, s[20:23], s34 offen offset:1280 sc1
    v_mfma_f32_16x16x32_bf16 v[36:39], a[132:135], a[212:215], v[36:39]
    buffer_store_dword v58, v13, s[20:23], s30 offen offset:128 sc1
    v_mfma_f32_16x16x32_bf16 v[40:43], a[156:159], a[212:215], v[40:43]
    v_cvt_pk_bf16_f32 v59, v233, v237
    v_cvt_pk_bf16_f32 v60, v234, v238
    v_mfma_f32_16x16x32_bf16 v[44:47], a[180:183], a[212:215], v[44:47]
    s_waitcnt lgkmcnt(0)
    v_cvt_pk_bf16_f32 v61, v235, v239
    v_cvt_pk_bf16_f32 v58, v240, v244
    v_mfma_f32_16x16x32_bf16 v[32:35], a[112:115], a[216:219], v[32:35]
    buffer_store_dword v59, v13, s[20:23], s30 offen offset:512 sc1
    v_mfma_f32_16x16x32_bf16 v[36:39], a[136:139], a[216:219], v[36:39]
    buffer_store_dword v60, v13, s[20:23], s30 offen offset:896 sc1
    v_mfma_f32_16x16x32_bf16 v[40:43], a[160:163], a[216:219], v[40:43]
    v_cvt_pk_bf16_f32 v59, v241, v245
    v_mfma_f32_16x16x32_bf16 v[44:47], a[184:187], a[216:219], v[44:47]
    buffer_store_dword v61, v13, s[20:23], s30 offen offset:1280 sc1
    v_mfma_f32_16x16x32_bf16 v[32:35], a[116:119], a[220:223], v[32:35]
    v_cvt_pk_bf16_f32 v60, v242, v246
    v_mfma_f32_16x16x32_bf16 v[36:39], a[140:143], a[220:223], v[36:39]
    buffer_store_dword v58, v13, s[20:23], s31 offen offset:128 sc1
    v_mfma_f32_16x16x32_bf16 v[40:43], a[164:167], a[220:223], v[40:43]
    v_cvt_pk_bf16_f32 v61, v243, v247
    v_mfma_f32_16x16x32_bf16 v[44:47], a[188:191], a[220:223], v[44:47]
    v_mfma_f32_16x16x32_bf16 v[64:67], v[160:163], v[136:139], 0
    buffer_store_dword v59, v13, s[20:23], s31 offen offset:512 sc1
    v_mfma_f32_16x16x32_bf16 v[72:75], v[168:171], v[136:139], 0
    buffer_store_dword v60, v13, s[20:23], s31 offen offset:896 sc1
    v_mfma_f32_16x16x32_bf16 v[80:83], v[176:179], v[136:139], 0
    v_mfma_f32_16x16x32_bf16 v[88:91], v[184:187], v[136:139], 0
    buffer_store_dword v61, v13, s[20:23], s31 offen offset:1280 sc1
    v_mfma_f32_16x16x32_bf16 v[64:67], v[164:167], v[140:143], v[64:67]
    v_cvt_pk_bf16_f32 v144, v32, v33
    v_cvt_pk_bf16_f32 v145, v34, v35
    v_mfma_f32_16x16x32_bf16 v[72:75], v[172:175], v[140:143], v[72:75]
    v_cvt_pk_bf16_f32 v146, v36, v37
    v_cvt_pk_bf16_f32 v147, v38, v39
    v_mfma_f32_16x16x32_bf16 v[80:83], v[180:183], v[140:143], v[80:83]
    v_cvt_pk_bf16_f32 v148, v40, v41
    v_cvt_pk_bf16_f32 v149, v42, v43
    v_mfma_f32_16x16x32_bf16 v[88:91], v[188:191], v[140:143], v[88:91]
    v_cvt_pk_bf16_f32 v150, v44, v45
    v_cvt_pk_bf16_f32 v151, v46, v47
    v_mfma_f32_16x16x32_bf16 v[68:71], v[160:163], v[144:147], 0
    s_nop 0
    v_mfma_f32_16x16x32_bf16 v[68:71], v[164:167], v[148:151], v[68:71]
    v_mfma_f32_16x16x32_bf16 v[76:79], v[168:171], v[144:147], 0
    v_mfma_f32_16x16x32_bf16 v[76:79], v[172:175], v[148:151], v[76:79]
    v_mfma_f32_16x16x32_bf16 v[84:87], v[176:179], v[144:147], 0
    v_mfma_f32_16x16x32_bf16 v[84:87], v[180:183], v[148:151], v[84:87]
    v_mfma_f32_16x16x32_bf16 v[92:95], v[184:187], v[144:147], 0
    v_mfma_f32_16x16x32_bf16 v[92:95], v[188:191], v[148:151], v[92:95]
    s_nop 1
    v_cvt_pk_bf16_f32 v16, v64, v68
    buffer_store_dword v16, v13, s[20:23], s32 offen offset:256 sc1
    v_cvt_pk_bf16_f32 v17, v65, v69
    buffer_store_dword v17, v13, s[20:23], s32 offen offset:640 sc1
    v_cvt_pk_bf16_f32 v18, v66, v70
    buffer_store_dword v18, v13, s[20:23], s32 offen offset:1024 sc1
    v_cvt_pk_bf16_f32 v19, v67, v71
    buffer_store_dword v19, v13, s[20:23], s32 offen offset:1408 sc1
    v_cvt_pk_bf16_f32 v20, v72, v76
    buffer_store_dword v20, v13, s[20:23], s34 offen offset:256 sc1
    v_cvt_pk_bf16_f32 v21, v73, v77
    buffer_store_dword v21, v13, s[20:23], s34 offen offset:640 sc1
    v_cvt_pk_bf16_f32 v22, v74, v78
    buffer_store_dword v22, v13, s[20:23], s34 offen offset:1024 sc1
    v_cvt_pk_bf16_f32 v23, v75, v79
    buffer_store_dword v23, v13, s[20:23], s34 offen offset:1408 sc1
    v_cvt_pk_bf16_f32 v24, v80, v84
    buffer_store_dword v24, v13, s[20:23], s30 offen offset:256 sc1
    v_cvt_pk_bf16_f32 v25, v81, v85
    buffer_store_dword v25, v13, s[20:23], s30 offen offset:640 sc1
    v_cvt_pk_bf16_f32 v26, v82, v86
    buffer_store_dword v26, v13, s[20:23], s30 offen offset:1024 sc1
    v_cvt_pk_bf16_f32 v27, v83, v87
    buffer_store_dword v27, v13, s[20:23], s30 offen offset:1408 sc1
    v_cvt_pk_bf16_f32 v28, v88, v92
    buffer_store_dword v28, v13, s[20:23], s31 offen offset:256 sc1
    v_cvt_pk_bf16_f32 v29, v89, v93
    buffer_store_dword v29, v13, s[20:23], s31 offen offset:640 sc1
    v_cvt_pk_bf16_f32 v30, v90, v94
    buffer_store_dword v30, v13, s[20:23], s31 offen offset:1024 sc1
    v_cvt_pk_bf16_f32 v31, v91, v95
    buffer_store_dword v31, v13, s[20:23], s31 offen offset:1408 sc1
done:
    s_endpgm
slowm:
    s_mov_b32 s92, s12
    s_and_b32 s93, s13, 0xffff
    s_mov_b32 s94, 256
    s_mov_b32 s95, 0x20000
    v_subrev_u32 v16, 256, v11
    v_min_u32 v17, 23, v0
    v_lshlrev_b32 v17, 7, v17
    v_add_u32 v17, 262144, v17
    s_mov_b32 s45, 0x80000
    s_mov_b32 s41, s54
pollm:
    buffer_load_dwordx2 v[18:19], off, s[92:95], 0 offset:128 sc1
    buffer_load_dwordx2 v[20:21], v16, s[24:27], 0 offen sc1
    s_sub_u32 s45, s45, 1
    s_cbranch_scc1 mok
    s_waitcnt vmcnt(0)
    v_readfirstlane_b32 s46, v18
    v_readfirstlane_b32 s47, v19
    s_add_u32 s42, s46, s55
    s_add_u32 s42, s42, 1
    s_mov_b32 s43, s47
    v_cmp_eq_u64 vcc, s[42:43], v[20:21]
    s_cmp_eq_u64 s[46:47], 0
    s_cbranch_scc1 pollm
    s_cmp_eq_u32 vcc_lo, -1
    s_cbranch_scc1 mok
    s_and_b32 s40, s45, 7
    s_cbranch_scc1 pollm
    buffer_load_dwordx2 v[20:21], v17, s[24:27], 0 offen sc1
    s_waitcnt vmcnt(0)
    v_cmp_eq_u64 vcc, s[46:47], v[20:21]
    s_nop 0
    s_cmp_eq_u32 vcc_lo, -1
    s_cbranch_scc0 pollm
    s_mov_b32 s41, 0
    v_mov_b32 v11, v17
    s_mov_b64 s[42:43], s[46:47]
    s_branch mok
polln:
    s_mov_b32 s45, 0x80000
polln2:
    buffer_load_dwordx2 v[14:15], v11, s[24:27], 0 offen sc1
    s_sub_u32 s45, s45, 1
    s_cbranch_scc1 polln3
    s_waitcnt vmcnt(0)
    v_cmp_eq_u64 vcc, s[42:43], v[14:15]
    s_nop 0
    s_cmp_eq_u32 vcc_lo, -1
    s_cbranch_scc0 polln2
polln3:
    s_waitcnt vmcnt(0)
    s_branch nok
code_end:
.section .rodata,"a"
.p2align 6
.amdhsa_kernel standalone__swin_window_attn__vision_kernel
  .amdhsa_next_free_vgpr 480
  .amdhsa_next_free_sgpr 102
  .amdhsa_accum_offset 256
  .amdhsa_group_segment_fixed_size 0
  .amdhsa_kernarg_size 48
  .amdhsa_user_sgpr_count 2
  .amdhsa_user_sgpr_kernarg_segment_ptr 1
  .amdhsa_system_sgpr_workgroup_id_x 1
.end_amdhsa_kernel
```
